```python
import torch

def _softmax(x, axis=-1):
    return torch.softmax(x, dim=axis)
def _gelu(x):
    return torch.nn.functional.gelu(x, approximate="tanh")
def _silu(x):
    return torch.nn.functional.silu(x)
def _sigmoid(x):
    return torch.sigmoid(x)
def _layernorm(x, axis=-1, eps=1e-5):
    m = x.mean(dim=axis, keepdim=True)
    v = x.var(dim=axis, keepdim=True, unbiased=False)
    return (x - m) / torch.sqrt(v + eps)
def _scatter_add(tgt, idx, src, axis=0):
    return tgt.clone().index_add_(axis, idx, src)
def _segment_sum(src, seg, n):
    out = torch.zeros((n,) + src.shape[1:], dtype=src.dtype)
    return out.index_add_(0, seg, src)
def _pad(x, pw):
    flat = tuple(v for pair in reversed(pw) for v in pair)
    return torch.nn.functional.pad(x, flat)

kernel_name = 'gated_mix__mha_block_cached__mixer_channel_mlp__decode'

def setup_inputs():

    _w = (lambda a: (lambda t: t.to(torch.bfloat16) if t.is_floating_point() else t)(torch.as_tensor(a)))
    def _A_setup():
        B, Sq, D = 8, 1, 576
        H, Sk, Dh = 32, 4096, 128
        return {
            "x": _w((lambda *s: torch.randn(*s, dtype=torch.bfloat16) * 0.05)(B, Sq, D)),
            "k_cache": _w((lambda *s: torch.randn(*s, dtype=torch.bfloat16) * 6.4)(B, H, Sk, Dh)),
            "v_cache": _w((lambda *s: torch.randn(*s, dtype=torch.bfloat16) * 0.4)(B, H, Sk, Dh)),
            "wq": _w((lambda *s: torch.randn(*s, dtype=torch.bfloat16) * 6.4)(D, H * Dh) * (D ** -0.5)),
            "wo": _w((lambda *s: torch.randn(*s, dtype=torch.bfloat16) * 0.4)(H * Dh, D) * ((H * Dh) ** -0.5)),
        }
    _A_in = _A_setup()

    def _B_setup():
        B, S, D, F = 8, 1, 576, 4608
        return {
            "x": _w((lambda *s: torch.randn(*s, dtype=torch.bfloat16) * 0.05)(B, S, D)),
            "w1": _w((lambda *s: torch.randn(*s, dtype=torch.bfloat16) * 0.8)(D, F) * (D ** -0.5)),
            "b1": _w((lambda *s: torch.randn(*s, dtype=torch.bfloat16) * 0.8)(F)),
            "w2": _w((lambda *s: torch.randn(*s, dtype=torch.bfloat16) * 0.05)(F, D) * (F ** -0.5)),
            "b2": _w((lambda *s: torch.randn(*s, dtype=torch.bfloat16) * 0.05)(D)),
        }
    _B_in = _B_setup()

    return {
        "A_x": _A_in["x"],
        "A_k_cache": _A_in["k_cache"],
        "A_v_cache": _A_in["v_cache"],
        "A_wq": _A_in["wq"],
        "A_wo": _A_in["wo"],
        "B_x": _B_in["x"],
        "B_w1": _B_in["w1"],
        "B_b1": _B_in["b1"],
        "B_w2": _B_in["w2"],
        "B_b2": _B_in["b2"],
        "gate_w": _w((lambda *s: torch.randn(*s, dtype=torch.bfloat16) * 0.05)(576) * 16.0),
    }

def reference(A_x, A_k_cache, A_v_cache, A_wq, A_wo, B_x, B_w1, B_b1, B_w2, B_b2, gate_w):
    def _A_ref(x, k_cache, v_cache, wq, wo):
        B, Sq, D = x.shape
        H, Dh = 32, 128
        q = (lambda x, *d: x.permute(*d))((x @ wq).reshape(B, Sq, H, Dh), 0, 2, 1, 3)
        scores = torch.einsum("bhqd,bhkd->bhqk", q, k_cache) * (Dh ** -0.5)
        p = _softmax(scores, axis=-1)
        o = torch.einsum("bhqk,bhkd->bhqd", p, v_cache)
        return (lambda x, *d: x.permute(*d))(o, 0, 2, 1, 3).reshape(B, Sq, H * Dh) @ wo

    def _B_ref(x, w1, b1, w2, b2):
        y = _layernorm(x, axis=-1)
        h = _gelu(torch.einsum("bsd,df->bsf", y, w1) + b1)
        return torch.einsum("bsf,fd->bsd", h, w2) + b2

    x = A_x
    g = _sigmoid((x * gate_w).sum(-1, keepdims=True))
    a = _A_ref(x, A_k_cache, A_v_cache, A_wq, A_wo)
    b = _B_ref(x, B_w1, B_b1, B_w2, B_b2)
    return g * a + (1 - g) * b
```

```asm
; @launch grid=(256,1,1) block=(512,1,1) lds=39520
.amdgcn_target "amdgcn-amd-amdhsa--gfx950"
.text
.globl gated_mix__mha_block_cached__mixer_channel_mlp__decode_kernel
.p2align 8
.type gated_mix__mha_block_cached__mixer_channel_mlp__decode_kernel,@function
gated_mix__mha_block_cached__mixer_channel_mlp__decode_kernel:
  s_cmp_ge_u32 s2, 256
  s_cbranch_scc1 L_end
  s_load_dwordx16 s[16:31], s[0:1], 0
  s_load_dwordx8 s[32:39], s[0:1], 64
  s_load_dwordx4 s[40:43], s[0:1], 96
  v_lshrrev_b32 v1, 6, v0
  v_and_b32 v0, 63, v0
  v_lshlrev_b32 v2, 4, v0
  v_readfirstlane_b32 s3, v1
  s_and_b32 s4, s2, 7
  s_lshl_b32 s4, s4, 2
  s_bfe_u32 s7, s2, 0x20003
  s_or_b32 s4, s4, s7
  s_lshr_b32 s5, s2, 5
  s_lshl_b32 s6, s5, 5
  s_or_b32 s6, s6, s4
  s_lshl_b32 s9, s6, 20
  s_lshl_b32 s13, s3, 10
  s_mov_b32 s46, 0x100000
  s_mov_b32 s47, 0x20000
  v_lshrrev_b32 v3, 4, v0
  v_and_b32 v4, 15, v0
  s_mov_b32 s92, 0xffff0000
  s_mov_b32 s8, s13
  s_cmp_ge_u32 s3, 4
  s_cbranch_scc1 L_helper
  s_waitcnt lgkmcnt(0)
  s_add_u32 s44, s18, s9
  s_addc_u32 s45, s19, 0
  buffer_load_dwordx4 v[88:91], v2, s[44:47], s8 offen nt
  s_addk_i32 s8, 4096
  buffer_load_dwordx4 v[92:95], v2, s[44:47], s8 offen nt
  s_addk_i32 s8, 4096
  buffer_load_dwordx4 v[96:99], v2, s[44:47], s8 offen nt
  s_addk_i32 s8, 4096
  buffer_load_dwordx4 v[100:103], v2, s[44:47], s8 offen nt
  s_addk_i32 s8, 4096
  buffer_load_dwordx4 v[104:107], v2, s[44:47], s8 offen nt
  s_addk_i32 s8, 4096
  s_lshl_b32 s7, s5, 7
  s_add_u32 s7, s7, 3145728
  s_load_dword s26, s[42:43], s7
  s_add_u32 s14, s20, s9
  s_addc_u32 s15, s21, 0
  v_and_b32 v1, 2, v0
  v_cmp_ne_u32 s[94:95], 0, v1
  v_and_b32 v1, 1, v0
  v_cmp_ne_u32 s[96:97], 0, v1
  v_lshlrev_b32 v5, 5, v4
  v_lshl_add_u32 v5, v3, 3, v5
  s_lshl_b32 s7, s3, 9
  v_add_u32 v239, s7, v5
  s_lshl_b32 s7, s3, 12
  v_lshl_add_u32 v238, v0, 2, s7
  v_mov_b32 v240, 0
  v_mov_b32 v241, 0
  v_mov_b32 v242, 0
  v_mov_b32 v243, 0
  v_mov_b32 v244, 0
  v_mov_b32 v245, 0
  v_mov_b32 v246, 0
  v_mov_b32 v247, 0
  v_mov_b32 v248, 0xff800000
  v_mov_b32 v249, 0
  s_waitcnt vmcnt(4)
  buffer_load_dwordx4 v[108:111], v2, s[44:47], s8 offen nt
  s_addk_i32 s8, 4096
  s_waitcnt vmcnt(4)
  buffer_load_dwordx4 v[112:115], v2, s[44:47], s8 offen nt
  s_addk_i32 s8, 4096
  s_waitcnt vmcnt(4)
  buffer_load_dwordx4 v[116:119], v2, s[44:47], s8 offen nt
  s_addk_i32 s8, 4096
  s_waitcnt vmcnt(4)
  buffer_load_dwordx4 v[120:123], v2, s[44:47], s8 offen nt
  s_addk_i32 s8, 4096
  s_waitcnt vmcnt(4)
  buffer_load_dwordx4 v[124:127], v2, s[44:47], s8 offen nt
  s_addk_i32 s8, 4096
  s_waitcnt vmcnt(4)
  buffer_load_dwordx4 v[128:131], v2, s[44:47], s8 offen nt
  s_addk_i32 s8, 4096
  s_waitcnt vmcnt(4)
  buffer_load_dwordx4 v[132:135], v2, s[44:47], s8 offen nt
  s_addk_i32 s8, 4096
  s_waitcnt vmcnt(4)
  buffer_load_dwordx4 v[136:139], v2, s[44:47], s8 offen nt
  s_addk_i32 s8, 4096
  s_waitcnt vmcnt(4)
  buffer_load_dwordx4 v[140:143], v2, s[44:47], s8 offen nt
  s_addk_i32 s8, 4096
  s_waitcnt vmcnt(4)
  buffer_load_dwordx4 v[144:147], v2, s[44:47], s8 offen nt
  s_addk_i32 s8, 4096
  s_waitcnt vmcnt(4)
  buffer_load_dwordx4 v[148:151], v2, s[44:47], s8 offen nt
  s_addk_i32 s8, 4096
  s_waitcnt vmcnt(4)
  buffer_load_dwordx4 v[152:155], v2, s[44:47], s8 offen nt
  s_addk_i32 s8, 4096
  s_waitcnt vmcnt(4)
  buffer_load_dwordx4 v[156:159], v2, s[44:47], s8 offen nt
  s_addk_i32 s8, 4096
  s_waitcnt vmcnt(4)
  buffer_load_dwordx4 v[160:163], v2, s[44:47], s8 offen nt
  s_addk_i32 s8, 4096
  s_waitcnt vmcnt(4)
  buffer_load_dwordx4 v[164:167], v2, s[44:47], s8 offen nt
  s_addk_i32 s8, 4096
  s_waitcnt vmcnt(4)
  buffer_load_dwordx4 v[168:171], v2, s[44:47], s8 offen nt
  s_addk_i32 s8, 4096
  s_waitcnt vmcnt(4)
  buffer_load_dwordx4 v[172:175], v2, s[44:47], s8 offen nt
  s_addk_i32 s8, 4096
  s_waitcnt vmcnt(4)
  buffer_load_dwordx4 v[176:179], v2, s[44:47], s8 offen nt
  s_addk_i32 s8, 4096
  s_waitcnt vmcnt(4)
  buffer_load_dwordx4 v[180:183], v2, s[44:47], s8 offen nt
  s_addk_i32 s8, 4096
  s_waitcnt vmcnt(4)
  buffer_load_dwordx4 v[184:187], v2, s[44:47], s8 offen nt
  s_addk_i32 s8, 4096
  s_waitcnt vmcnt(4)
  buffer_load_dwordx4 v[188:191], v2, s[44:47], s8 offen nt
  s_addk_i32 s8, 4096
  s_waitcnt vmcnt(4)
  buffer_load_dwordx4 v[192:195], v2, s[44:47], s8 offen nt
  s_addk_i32 s8, 4096
  s_waitcnt vmcnt(4)
  buffer_load_dwordx4 v[196:199], v2, s[44:47], s8 offen nt
  s_addk_i32 s8, 4096
  s_waitcnt vmcnt(4)
  buffer_load_dwordx4 v[200:203], v2, s[44:47], s8 offen nt
  s_addk_i32 s8, 4096
  s_waitcnt vmcnt(4)
  buffer_load_dwordx4 v[204:207], v2, s[44:47], s8 offen nt
  s_addk_i32 s8, 4096
  s_waitcnt vmcnt(4)
  buffer_load_dwordx4 v[208:211], v2, s[44:47], s8 offen nt
  s_addk_i32 s8, 4096
  s_waitcnt vmcnt(4)
  buffer_load_dwordx4 v[212:215], v2, s[44:47], s8 offen nt
  s_addk_i32 s8, 4096
  s_waitcnt vmcnt(4)
  buffer_load_dwordx4 v[24:27], v2, s[44:47], s8 offen nt
  s_addk_i32 s8, 4096
  s_waitcnt vmcnt(4)
  buffer_load_dwordx4 v[28:31], v2, s[44:47], s8 offen nt
  s_addk_i32 s8, 4096
  s_waitcnt vmcnt(4)
  buffer_load_dwordx4 v[32:35], v2, s[44:47], s8 offen nt
  s_addk_i32 s8, 4096
  s_waitcnt vmcnt(4)
  buffer_load_dwordx4 v[36:39], v2, s[44:47], s8 offen nt
  s_addk_i32 s8, 4096
  s_waitcnt vmcnt(4)
  buffer_load_dwordx4 v[40:43], v2, s[44:47], s8 offen nt
  s_addk_i32 s8, 4096
  s_waitcnt vmcnt(4)
  buffer_load_dwordx4 v[44:47], v2, s[44:47], s8 offen nt
  s_addk_i32 s8, 4096
  s_waitcnt vmcnt(4)
  buffer_load_dwordx4 v[48:51], v2, s[44:47], s8 offen nt
  s_addk_i32 s8, 4096
  s_waitcnt vmcnt(4)
  buffer_load_dwordx4 v[52:55], v2, s[44:47], s8 offen nt
  s_addk_i32 s8, 4096
  s_waitcnt vmcnt(4)
  buffer_load_dwordx4 v[56:59], v2, s[44:47], s8 offen nt
  s_addk_i32 s8, 4096
  s_waitcnt vmcnt(4)
  buffer_load_dwordx4 v[60:63], v2, s[44:47], s8 offen nt
  s_addk_i32 s8, 4096
  s_waitcnt vmcnt(4)
  buffer_load_dwordx4 v[64:67], v2, s[44:47], s8 offen nt
  s_addk_i32 s8, 4096
  s_waitcnt vmcnt(4)
  buffer_load_dwordx4 v[68:71], v2, s[44:47], s8 offen nt
  s_addk_i32 s8, 4096
  s_barrier
  buffer_load_dwordx4 v[72:75], v2, s[44:47], s8 offen nt
  s_addk_i32 s8, 4096
  buffer_load_dwordx4 v[76:79], v2, s[44:47], s8 offen nt
  s_addk_i32 s8, 4096
  buffer_load_dwordx4 v[80:83], v2, s[44:47], s8 offen nt
  s_addk_i32 s8, 4096
  buffer_load_dwordx4 v[84:87], v2, s[44:47], s8 offen nt
  s_addk_i32 s8, 4096
  v_lshlrev_b32 v5, 5, v4
  ds_read_b128 v[216:219], v5 offset:0
  ds_read_b128 v[220:223], v5 offset:16
  ds_read_b128 v[224:227], v5 offset:512
  ds_read_b128 v[228:231], v5 offset:528
  ds_read_b128 v[8:11], v5 offset:1024
  ds_read_b128 v[12:15], v5 offset:1040
  ds_read_b128 v[16:19], v5 offset:1536
  ds_read_b128 v[20:23], v5 offset:1552
  s_waitcnt lgkmcnt(0)
  v_add_f32 v216, v216, v224
  v_add_f32 v8, v8, v16
  v_add_f32 v217, v217, v225
  v_add_f32 v9, v9, v17
  v_add_f32 v218, v218, v226
  v_add_f32 v10, v10, v18
  v_add_f32 v219, v219, v227
  v_add_f32 v11, v11, v19
  v_add_f32 v220, v220, v228
  v_add_f32 v12, v12, v20
  v_add_f32 v221, v221, v229
  v_add_f32 v13, v13, v21
  v_add_f32 v222, v222, v230
  v_add_f32 v14, v14, v22
  v_add_f32 v223, v223, v231
  v_add_f32 v15, v15, v23
  v_add_f32 v216, v216, v8
  v_add_f32 v217, v217, v9
  v_add_f32 v218, v218, v10
  v_add_f32 v219, v219, v11
  v_add_f32 v220, v220, v12
  v_add_f32 v221, v221, v13
  v_add_f32 v222, v222, v14
  v_add_f32 v223, v223, v15
  v_cvt_pk_bf16_f32 v232, v216, v217
  v_cvt_pk_bf16_f32 v233, v218, v219
  v_cvt_pk_bf16_f32 v234, v220, v221
  v_cvt_pk_bf16_f32 v235, v222, v223
  v_dot2_f32_bf16 v216, v88, v232, 0
  v_dot2_f32_bf16 v216, v89, v233, v216
  v_dot2_f32_bf16 v216, v90, v234, v216
  v_dot2_f32_bf16 v216, v91, v235, v216
  v_dot2_f32_bf16 v217, v92, v232, 0
  v_dot2_f32_bf16 v217, v93, v233, v217
  v_dot2_f32_bf16 v217, v94, v234, v217
  v_dot2_f32_bf16 v217, v95, v235, v217
  v_dot2_f32_bf16 v218, v96, v232, 0
  v_dot2_f32_bf16 v218, v97, v233, v218
  v_dot2_f32_bf16 v218, v98, v234, v218
  v_dot2_f32_bf16 v218, v99, v235, v218
  v_dot2_f32_bf16 v219, v100, v232, 0
  v_dot2_f32_bf16 v219, v101, v233, v219
  v_dot2_f32_bf16 v219, v102, v234, v219
  v_dot2_f32_bf16 v219, v103, v235, v219
  v_dot2_f32_bf16 v220, v104, v232, 0
  v_dot2_f32_bf16 v220, v105, v233, v220
  v_dot2_f32_bf16 v220, v106, v234, v220
  v_dot2_f32_bf16 v220, v107, v235, v220
  v_dot2_f32_bf16 v221, v108, v232, 0
  v_dot2_f32_bf16 v221, v109, v233, v221
  v_dot2_f32_bf16 v221, v110, v234, v221
  v_dot2_f32_bf16 v221, v111, v235, v221
  v_dot2_f32_bf16 v222, v112, v232, 0
  v_dot2_f32_bf16 v222, v113, v233, v222
  v_dot2_f32_bf16 v222, v114, v234, v222
  v_dot2_f32_bf16 v222, v115, v235, v222
  v_dot2_f32_bf16 v223, v116, v232, 0
  v_dot2_f32_bf16 v223, v117, v233, v223
  v_dot2_f32_bf16 v223, v118, v234, v223
  v_dot2_f32_bf16 v223, v119, v235, v223
  v_dot2_f32_bf16 v224, v120, v232, 0
  v_dot2_f32_bf16 v224, v121, v233, v224
  v_dot2_f32_bf16 v224, v122, v234, v224
  v_dot2_f32_bf16 v224, v123, v235, v224
  v_dot2_f32_bf16 v225, v124, v232, 0
  v_dot2_f32_bf16 v225, v125, v233, v225
  v_dot2_f32_bf16 v225, v126, v234, v225
  v_dot2_f32_bf16 v225, v127, v235, v225
  v_dot2_f32_bf16 v226, v128, v232, 0
  v_dot2_f32_bf16 v226, v129, v233, v226
  v_dot2_f32_bf16 v226, v130, v234, v226
  v_dot2_f32_bf16 v226, v131, v235, v226
  v_dot2_f32_bf16 v227, v132, v232, 0
  v_dot2_f32_bf16 v227, v133, v233, v227
  v_dot2_f32_bf16 v227, v134, v234, v227
  v_dot2_f32_bf16 v227, v135, v235, v227
  v_dot2_f32_bf16 v228, v136, v232, 0
  v_dot2_f32_bf16 v228, v137, v233, v228
  v_dot2_f32_bf16 v228, v138, v234, v228
  v_dot2_f32_bf16 v228, v139, v235, v228
  v_dot2_f32_bf16 v229, v140, v232, 0
  v_dot2_f32_bf16 v229, v141, v233, v229
  v_dot2_f32_bf16 v229, v142, v234, v229
  v_dot2_f32_bf16 v229, v143, v235, v229
  v_dot2_f32_bf16 v230, v144, v232, 0
  v_dot2_f32_bf16 v230, v145, v233, v230
  v_dot2_f32_bf16 v230, v146, v234, v230
  v_dot2_f32_bf16 v230, v147, v235, v230
  v_dot2_f32_bf16 v231, v148, v232, 0
  v_dot2_f32_bf16 v231, v149, v233, v231
  v_dot2_f32_bf16 v231, v150, v234, v231
  v_dot2_f32_bf16 v231, v151, v235, v231
  v_add_f32_dpp v216, v216, v216 row_ror:8 row_mask:0xf bank_mask:0x3
  s_nop 1
  v_add_f32_dpp v216, v224, v224 row_ror:8 row_mask:0xf bank_mask:0xc
  v_add_f32_dpp v217, v217, v217 row_ror:8 row_mask:0xf bank_mask:0x3
  s_nop 1
  v_add_f32_dpp v217, v225, v225 row_ror:8 row_mask:0xf bank_mask:0xc
  v_add_f32_dpp v218, v218, v218 row_ror:8 row_mask:0xf bank_mask:0x3
  s_nop 1
  v_add_f32_dpp v218, v226, v226 row_ror:8 row_mask:0xf bank_mask:0xc
  v_add_f32_dpp v219, v219, v219 row_ror:8 row_mask:0xf bank_mask:0x3
  s_nop 1
  v_add_f32_dpp v219, v227, v227 row_ror:8 row_mask:0xf bank_mask:0xc
  v_add_f32_dpp v220, v220, v220 row_ror:8 row_mask:0xf bank_mask:0x3
  s_nop 1
  v_add_f32_dpp v220, v228, v228 row_ror:8 row_mask:0xf bank_mask:0xc
  v_add_f32_dpp v221, v221, v221 row_ror:8 row_mask:0xf bank_mask:0x3
  s_nop 1
  v_add_f32_dpp v221, v229, v229 row_ror:8 row_mask:0xf bank_mask:0xc
  v_add_f32_dpp v222, v222, v222 row_ror:8 row_mask:0xf bank_mask:0x3
  s_nop 1
  v_add_f32_dpp v222, v230, v230 row_ror:8 row_mask:0xf bank_mask:0xc
  v_add_f32_dpp v223, v223, v223 row_ror:8 row_mask:0xf bank_mask:0x3
  s_nop 1
  v_add_f32_dpp v223, v231, v231 row_ror:8 row_mask:0xf bank_mask:0xc
  v_add_f32_dpp v216, v216, v216 row_shl:4 row_mask:0xf bank_mask:0x5
  s_nop 1
  v_add_f32_dpp v216, v220, v220 row_shr:4 row_mask:0xf bank_mask:0xa
  v_add_f32_dpp v217, v217, v217 row_shl:4 row_mask:0xf bank_mask:0x5
  s_nop 1
  v_add_f32_dpp v217, v221, v221 row_shr:4 row_mask:0xf bank_mask:0xa
  v_add_f32_dpp v218, v218, v218 row_shl:4 row_mask:0xf bank_mask:0x5
  s_nop 1
  v_add_f32_dpp v218, v222, v222 row_shr:4 row_mask:0xf bank_mask:0xa
  v_add_f32_dpp v219, v219, v219 row_shl:4 row_mask:0xf bank_mask:0x5
  s_nop 1
  v_add_f32_dpp v219, v223, v223 row_shr:4 row_mask:0xf bank_mask:0xa
  v_cndmask_b32 v16, v216, v218, s[94:95]
  v_cndmask_b32 v18, v218, v216, s[94:95]
  v_cndmask_b32 v17, v217, v219, s[94:95]
  v_cndmask_b32 v19, v219, v217, s[94:95]
  v_add_f32_dpp v16, v18, v16 quad_perm:[2,3,0,1] row_mask:0xf bank_mask:0xf
  s_nop 0
  v_add_f32_dpp v17, v19, v17 quad_perm:[2,3,0,1] row_mask:0xf bank_mask:0xf
  v_cndmask_b32 v20, v16, v17, s[96:97]
  v_cndmask_b32 v21, v17, v16, s[96:97]
  s_nop 1
  v_add_f32_dpp v20, v21, v20 quad_perm:[1,0,3,2] row_mask:0xf bank_mask:0xf
  ds_write_b32 v238, v20 offset:4096
  v_max_f32 v248, v248, v20
  v_add_u32 v238, 256, v238
  v_dot2_f32_bf16 v216, v152, v232, 0
  v_dot2_f32_bf16 v216, v153, v233, v216
  v_dot2_f32_bf16 v216, v154, v234, v216
  v_dot2_f32_bf16 v216, v155, v235, v216
  v_dot2_f32_bf16 v217, v156, v232, 0
  v_dot2_f32_bf16 v217, v157, v233, v217
  v_dot2_f32_bf16 v217, v158, v234, v217
  v_dot2_f32_bf16 v217, v159, v235, v217
  v_dot2_f32_bf16 v218, v160, v232, 0
  v_dot2_f32_bf16 v218, v161, v233, v218
  v_dot2_f32_bf16 v218, v162, v234, v218
  v_dot2_f32_bf16 v218, v163, v235, v218
  v_dot2_f32_bf16 v219, v164, v232, 0
  v_dot2_f32_bf16 v219, v165, v233, v219
  v_dot2_f32_bf16 v219, v166, v234, v219
  v_dot2_f32_bf16 v219, v167, v235, v219
  v_dot2_f32_bf16 v220, v168, v232, 0
  v_dot2_f32_bf16 v220, v169, v233, v220
  v_dot2_f32_bf16 v220, v170, v234, v220
  v_dot2_f32_bf16 v220, v171, v235, v220
  v_dot2_f32_bf16 v221, v172, v232, 0
  v_dot2_f32_bf16 v221, v173, v233, v221
  v_dot2_f32_bf16 v221, v174, v234, v221
  v_dot2_f32_bf16 v221, v175, v235, v221
  v_dot2_f32_bf16 v222, v176, v232, 0
  v_dot2_f32_bf16 v222, v177, v233, v222
  v_dot2_f32_bf16 v222, v178, v234, v222
  v_dot2_f32_bf16 v222, v179, v235, v222
  v_dot2_f32_bf16 v223, v180, v232, 0
  v_dot2_f32_bf16 v223, v181, v233, v223
  v_dot2_f32_bf16 v223, v182, v234, v223
  v_dot2_f32_bf16 v223, v183, v235, v223
  v_dot2_f32_bf16 v224, v184, v232, 0
  v_dot2_f32_bf16 v224, v185, v233, v224
  v_dot2_f32_bf16 v224, v186, v234, v224
  v_dot2_f32_bf16 v224, v187, v235, v224
  v_dot2_f32_bf16 v225, v188, v232, 0
  v_dot2_f32_bf16 v225, v189, v233, v225
  v_dot2_f32_bf16 v225, v190, v234, v225
  v_dot2_f32_bf16 v225, v191, v235, v225
  v_dot2_f32_bf16 v226, v192, v232, 0
  v_dot2_f32_bf16 v226, v193, v233, v226
  v_dot2_f32_bf16 v226, v194, v234, v226
  v_dot2_f32_bf16 v226, v195, v235, v226
  v_dot2_f32_bf16 v227, v196, v232, 0
  v_dot2_f32_bf16 v227, v197, v233, v227
  v_dot2_f32_bf16 v227, v198, v234, v227
  v_dot2_f32_bf16 v227, v199, v235, v227
  v_dot2_f32_bf16 v228, v200, v232, 0
  v_dot2_f32_bf16 v228, v201, v233, v228
  v_dot2_f32_bf16 v228, v202, v234, v228
  v_dot2_f32_bf16 v228, v203, v235, v228
  v_dot2_f32_bf16 v229, v204, v232, 0
  v_dot2_f32_bf16 v229, v205, v233, v229
  v_dot2_f32_bf16 v229, v206, v234, v229
  v_dot2_f32_bf16 v229, v207, v235, v229
  v_dot2_f32_bf16 v230, v208, v232, 0
  v_dot2_f32_bf16 v230, v209, v233, v230
  v_dot2_f32_bf16 v230, v210, v234, v230
  v_dot2_f32_bf16 v230, v211, v235, v230
  v_dot2_f32_bf16 v231, v212, v232, 0
  v_dot2_f32_bf16 v231, v213, v233, v231
  v_dot2_f32_bf16 v231, v214, v234, v231
  v_dot2_f32_bf16 v231, v215, v235, v231
  v_add_f32_dpp v216, v216, v216 row_ror:8 row_mask:0xf bank_mask:0x3
  s_nop 1
  v_add_f32_dpp v216, v224, v224 row_ror:8 row_mask:0xf bank_mask:0xc
  v_add_f32_dpp v217, v217, v217 row_ror:8 row_mask:0xf bank_mask:0x3
  s_nop 1
  v_add_f32_dpp v217, v225, v225 row_ror:8 row_mask:0xf bank_mask:0xc
  v_add_f32_dpp v218, v218, v218 row_ror:8 row_mask:0xf bank_mask:0x3
  s_nop 1
  v_add_f32_dpp v218, v226, v226 row_ror:8 row_mask:0xf bank_mask:0xc
  v_add_f32_dpp v219, v219, v219 row_ror:8 row_mask:0xf bank_mask:0x3
  s_nop 1
  v_add_f32_dpp v219, v227, v227 row_ror:8 row_mask:0xf bank_mask:0xc
  v_add_f32_dpp v220, v220, v220 row_ror:8 row_mask:0xf bank_mask:0x3
  s_nop 1
  v_add_f32_dpp v220, v228, v228 row_ror:8 row_mask:0xf bank_mask:0xc
  v_add_f32_dpp v221, v221, v221 row_ror:8 row_mask:0xf bank_mask:0x3
  s_nop 1
  v_add_f32_dpp v221, v229, v229 row_ror:8 row_mask:0xf bank_mask:0xc
  v_add_f32_dpp v222, v222, v222 row_ror:8 row_mask:0xf bank_mask:0x3
  s_nop 1
  v_add_f32_dpp v222, v230, v230 row_ror:8 row_mask:0xf bank_mask:0xc
  v_add_f32_dpp v223, v223, v223 row_ror:8 row_mask:0xf bank_mask:0x3
  s_nop 1
  v_add_f32_dpp v223, v231, v231 row_ror:8 row_mask:0xf bank_mask:0xc
  v_add_f32_dpp v216, v216, v216 row_shl:4 row_mask:0xf bank_mask:0x5
  s_nop 1
  v_add_f32_dpp v216, v220, v220 row_shr:4 row_mask:0xf bank_mask:0xa
  v_add_f32_dpp v217, v217, v217 row_shl:4 row_mask:0xf bank_mask:0x5
  s_nop 1
  v_add_f32_dpp v217, v221, v221 row_shr:4 row_mask:0xf bank_mask:0xa
  v_add_f32_dpp v218, v218, v218 row_shl:4 row_mask:0xf bank_mask:0x5
  s_nop 1
  v_add_f32_dpp v218, v222, v222 row_shr:4 row_mask:0xf bank_mask:0xa
  v_add_f32_dpp v219, v219, v219 row_shl:4 row_mask:0xf bank_mask:0x5
  s_nop 1
  v_add_f32_dpp v219, v223, v223 row_shr:4 row_mask:0xf bank_mask:0xa
  v_cndmask_b32 v16, v216, v218, s[94:95]
  v_cndmask_b32 v18, v218, v216, s[94:95]
  v_cndmask_b32 v17, v217, v219, s[94:95]
  v_cndmask_b32 v19, v219, v217, s[94:95]
  v_add_f32_dpp v16, v18, v16 quad_perm:[2,3,0,1] row_mask:0xf bank_mask:0xf
  s_nop 0
  v_add_f32_dpp v17, v19, v17 quad_perm:[2,3,0,1] row_mask:0xf bank_mask:0xf
  v_cndmask_b32 v20, v16, v17, s[96:97]
  v_cndmask_b32 v21, v17, v16, s[96:97]
  s_nop 1
  v_add_f32_dpp v20, v21, v20 quad_perm:[1,0,3,2] row_mask:0xf bank_mask:0xf
  ds_write_b32 v238, v20 offset:4096
  v_max_f32 v248, v248, v20
  v_add_u32 v238, 256, v238
  v_dot2_f32_bf16 v216, v24, v232, 0
  v_dot2_f32_bf16 v216, v25, v233, v216
  v_dot2_f32_bf16 v216, v26, v234, v216
  v_dot2_f32_bf16 v216, v27, v235, v216
  v_dot2_f32_bf16 v217, v28, v232, 0
  v_dot2_f32_bf16 v217, v29, v233, v217
  v_dot2_f32_bf16 v217, v30, v234, v217
  v_dot2_f32_bf16 v217, v31, v235, v217
  v_dot2_f32_bf16 v218, v32, v232, 0
  v_dot2_f32_bf16 v218, v33, v233, v218
  v_dot2_f32_bf16 v218, v34, v234, v218
  v_dot2_f32_bf16 v218, v35, v235, v218
  v_dot2_f32_bf16 v219, v36, v232, 0
  v_dot2_f32_bf16 v219, v37, v233, v219
  v_dot2_f32_bf16 v219, v38, v234, v219
  v_dot2_f32_bf16 v219, v39, v235, v219
  v_dot2_f32_bf16 v220, v40, v232, 0
  v_dot2_f32_bf16 v220, v41, v233, v220
  v_dot2_f32_bf16 v220, v42, v234, v220
  v_dot2_f32_bf16 v220, v43, v235, v220
  v_dot2_f32_bf16 v221, v44, v232, 0
  v_dot2_f32_bf16 v221, v45, v233, v221
  v_dot2_f32_bf16 v221, v46, v234, v221
  v_dot2_f32_bf16 v221, v47, v235, v221
  v_dot2_f32_bf16 v222, v48, v232, 0
  v_dot2_f32_bf16 v222, v49, v233, v222
  v_dot2_f32_bf16 v222, v50, v234, v222
  v_dot2_f32_bf16 v222, v51, v235, v222
  s_waitcnt vmcnt(8)
  v_dot2_f32_bf16 v223, v52, v232, 0
  v_dot2_f32_bf16 v223, v53, v233, v223
  v_dot2_f32_bf16 v223, v54, v234, v223
  v_dot2_f32_bf16 v223, v55, v235, v223
  s_waitcnt vmcnt(7)
  v_dot2_f32_bf16 v224, v56, v232, 0
  v_dot2_f32_bf16 v224, v57, v233, v224
  v_dot2_f32_bf16 v224, v58, v234, v224
  v_dot2_f32_bf16 v224, v59, v235, v224
  s_waitcnt vmcnt(6)
  v_dot2_f32_bf16 v225, v60, v232, 0
  v_dot2_f32_bf16 v225, v61, v233, v225
  v_dot2_f32_bf16 v225, v62, v234, v225
  v_dot2_f32_bf16 v225, v63, v235, v225
  s_waitcnt vmcnt(5)
  v_dot2_f32_bf16 v226, v64, v232, 0
  v_dot2_f32_bf16 v226, v65, v233, v226
  v_dot2_f32_bf16 v226, v66, v234, v226
  v_dot2_f32_bf16 v226, v67, v235, v226
  s_waitcnt vmcnt(4)
  buffer_load_dwordx4 v[24:27], v2, s[44:47], s8 offen nt
  s_addk_i32 s8, 4096
  v_dot2_f32_bf16 v227, v68, v232, 0
  v_dot2_f32_bf16 v227, v69, v233, v227
  v_dot2_f32_bf16 v227, v70, v234, v227
  v_dot2_f32_bf16 v227, v71, v235, v227
  s_waitcnt vmcnt(4)
  buffer_load_dwordx4 v[28:31], v2, s[44:47], s8 offen nt
  s_addk_i32 s8, 4096
  v_dot2_f32_bf16 v228, v72, v232, 0
  v_dot2_f32_bf16 v228, v73, v233, v228
  v_dot2_f32_bf16 v228, v74, v234, v228
  v_dot2_f32_bf16 v228, v75, v235, v228
  s_waitcnt vmcnt(4)
  buffer_load_dwordx4 v[32:35], v2, s[44:47], s8 offen nt
  s_addk_i32 s8, 4096
  v_dot2_f32_bf16 v229, v76, v232, 0
  v_dot2_f32_bf16 v229, v77, v233, v229
  v_dot2_f32_bf16 v229, v78, v234, v229
  v_dot2_f32_bf16 v229, v79, v235, v229
  s_waitcnt vmcnt(4)
  buffer_load_dwordx4 v[36:39], v2, s[44:47], s8 offen nt
  s_addk_i32 s8, 4096
  v_dot2_f32_bf16 v230, v80, v232, 0
  v_dot2_f32_bf16 v230, v81, v233, v230
  v_dot2_f32_bf16 v230, v82, v234, v230
  v_dot2_f32_bf16 v230, v83, v235, v230
  s_waitcnt vmcnt(4)
  buffer_load_dwordx4 v[40:43], v2, s[44:47], s8 offen nt
  s_addk_i32 s8, 4096
  buffer_load_dwordx4 v[44:47], v2, s[44:47], s8 offen nt
  s_addk_i32 s8, 4096
  v_dot2_f32_bf16 v231, v84, v232, 0
  v_dot2_f32_bf16 v231, v85, v233, v231
  v_dot2_f32_bf16 v231, v86, v234, v231
  v_dot2_f32_bf16 v231, v87, v235, v231
  v_add_f32_dpp v216, v216, v216 row_ror:8 row_mask:0xf bank_mask:0x3
  s_nop 1
  v_add_f32_dpp v216, v224, v224 row_ror:8 row_mask:0xf bank_mask:0xc
  v_add_f32_dpp v217, v217, v217 row_ror:8 row_mask:0xf bank_mask:0x3
  s_nop 1
  v_add_f32_dpp v217, v225, v225 row_ror:8 row_mask:0xf bank_mask:0xc
  v_add_f32_dpp v218, v218, v218 row_ror:8 row_mask:0xf bank_mask:0x3
  s_nop 1
  v_add_f32_dpp v218, v226, v226 row_ror:8 row_mask:0xf bank_mask:0xc
  v_add_f32_dpp v219, v219, v219 row_ror:8 row_mask:0xf bank_mask:0x3
  s_nop 1
  v_add_f32_dpp v219, v227, v227 row_ror:8 row_mask:0xf bank_mask:0xc
  v_add_f32_dpp v220, v220, v220 row_ror:8 row_mask:0xf bank_mask:0x3
  s_nop 1
  v_add_f32_dpp v220, v228, v228 row_ror:8 row_mask:0xf bank_mask:0xc
  v_add_f32_dpp v221, v221, v221 row_ror:8 row_mask:0xf bank_mask:0x3
  s_nop 1
  v_add_f32_dpp v221, v229, v229 row_ror:8 row_mask:0xf bank_mask:0xc
  v_add_f32_dpp v222, v222, v222 row_ror:8 row_mask:0xf bank_mask:0x3
  s_nop 1
  v_add_f32_dpp v222, v230, v230 row_ror:8 row_mask:0xf bank_mask:0xc
  v_add_f32_dpp v223, v223, v223 row_ror:8 row_mask:0xf bank_mask:0x3
  s_nop 1
  v_add_f32_dpp v223, v231, v231 row_ror:8 row_mask:0xf bank_mask:0xc
  v_add_f32_dpp v216, v216, v216 row_shl:4 row_mask:0xf bank_mask:0x5
  s_nop 1
  v_add_f32_dpp v216, v220, v220 row_shr:4 row_mask:0xf bank_mask:0xa
  v_add_f32_dpp v217, v217, v217 row_shl:4 row_mask:0xf bank_mask:0x5
  s_nop 1
  v_add_f32_dpp v217, v221, v221 row_shr:4 row_mask:0xf bank_mask:0xa
  v_add_f32_dpp v218, v218, v218 row_shl:4 row_mask:0xf bank_mask:0x5
  s_nop 1
  v_add_f32_dpp v218, v222, v222 row_shr:4 row_mask:0xf bank_mask:0xa
  v_add_f32_dpp v219, v219, v219 row_shl:4 row_mask:0xf bank_mask:0x5
  s_nop 1
  v_add_f32_dpp v219, v223, v223 row_shr:4 row_mask:0xf bank_mask:0xa
  v_cndmask_b32 v16, v216, v218, s[94:95]
  v_cndmask_b32 v18, v218, v216, s[94:95]
  v_cndmask_b32 v17, v217, v219, s[94:95]
  v_cndmask_b32 v19, v219, v217, s[94:95]
  v_add_f32_dpp v16, v18, v16 quad_perm:[2,3,0,1] row_mask:0xf bank_mask:0xf
  s_nop 0
  v_add_f32_dpp v17, v19, v17 quad_perm:[2,3,0,1] row_mask:0xf bank_mask:0xf
  v_cndmask_b32 v20, v16, v17, s[96:97]
  v_cndmask_b32 v21, v17, v16, s[96:97]
  s_nop 1
  v_add_f32_dpp v20, v21, v20 quad_perm:[1,0,3,2] row_mask:0xf bank_mask:0xf
  ds_write_b32 v238, v20 offset:4096
  v_max_f32 v248, v248, v20
  v_add_u32 v238, 256, v238
  s_mov_b32 s12, 3
L_kloop:
  s_waitcnt vmcnt(5)
  v_dot2_f32_bf16 v216, v24, v232, 0
  v_dot2_f32_bf16 v216, v25, v233, v216
  v_dot2_f32_bf16 v216, v26, v234, v216
  v_dot2_f32_bf16 v216, v27, v235, v216
  s_waitcnt vmcnt(4)
  buffer_load_dwordx4 v[48:51], v2, s[44:47], s8 offen nt
  s_addk_i32 s8, 4096
  v_dot2_f32_bf16 v217, v28, v232, 0
  v_dot2_f32_bf16 v217, v29, v233, v217
  v_dot2_f32_bf16 v217, v30, v234, v217
  v_dot2_f32_bf16 v217, v31, v235, v217
  s_waitcnt vmcnt(4)
  buffer_load_dwordx4 v[52:55], v2, s[44:47], s8 offen nt
  s_addk_i32 s8, 4096
  v_dot2_f32_bf16 v218, v32, v232, 0
  v_dot2_f32_bf16 v218, v33, v233, v218
  v_dot2_f32_bf16 v218, v34, v234, v218
  v_dot2_f32_bf16 v218, v35, v235, v218
  s_waitcnt vmcnt(4)
  buffer_load_dwordx4 v[56:59], v2, s[44:47], s8 offen nt
  s_addk_i32 s8, 4096
  v_dot2_f32_bf16 v219, v36, v232, 0
  v_dot2_f32_bf16 v219, v37, v233, v219
  v_dot2_f32_bf16 v219, v38, v234, v219
  v_dot2_f32_bf16 v219, v39, v235, v219
  s_waitcnt vmcnt(4)
  buffer_load_dwordx4 v[60:63], v2, s[44:47], s8 offen nt
  s_addk_i32 s8, 4096
  v_dot2_f32_bf16 v220, v40, v232, 0
  v_dot2_f32_bf16 v220, v41, v233, v220
  v_dot2_f32_bf16 v220, v42, v234, v220
  v_dot2_f32_bf16 v220, v43, v235, v220
  s_waitcnt vmcnt(4)
  buffer_load_dwordx4 v[64:67], v2, s[44:47], s8 offen nt
  s_addk_i32 s8, 4096
  v_dot2_f32_bf16 v221, v44, v232, 0
  v_dot2_f32_bf16 v221, v45, v233, v221
  v_dot2_f32_bf16 v221, v46, v234, v221
  v_dot2_f32_bf16 v221, v47, v235, v221
  s_waitcnt vmcnt(4)
  buffer_load_dwordx4 v[68:71], v2, s[44:47], s8 offen nt
  s_addk_i32 s8, 4096
  v_dot2_f32_bf16 v222, v48, v232, 0
  v_dot2_f32_bf16 v222, v49, v233, v222
  v_dot2_f32_bf16 v222, v50, v234, v222
  v_dot2_f32_bf16 v222, v51, v235, v222
  s_waitcnt vmcnt(4)
  buffer_load_dwordx4 v[72:75], v2, s[44:47], s8 offen nt
  s_addk_i32 s8, 4096
  v_dot2_f32_bf16 v223, v52, v232, 0
  v_dot2_f32_bf16 v223, v53, v233, v223
  v_dot2_f32_bf16 v223, v54, v234, v223
  v_dot2_f32_bf16 v223, v55, v235, v223
  s_waitcnt vmcnt(4)
  buffer_load_dwordx4 v[76:79], v2, s[44:47], s8 offen nt
  s_addk_i32 s8, 4096
  v_dot2_f32_bf16 v224, v56, v232, 0
  v_dot2_f32_bf16 v224, v57, v233, v224
  v_dot2_f32_bf16 v224, v58, v234, v224
  v_dot2_f32_bf16 v224, v59, v235, v224
  s_waitcnt vmcnt(4)
  buffer_load_dwordx4 v[80:83], v2, s[44:47], s8 offen nt
  s_addk_i32 s8, 4096
  v_dot2_f32_bf16 v225, v60, v232, 0
  v_dot2_f32_bf16 v225, v61, v233, v225
  v_dot2_f32_bf16 v225, v62, v234, v225
  v_dot2_f32_bf16 v225, v63, v235, v225
  s_waitcnt vmcnt(4)
  buffer_load_dwordx4 v[84:87], v2, s[44:47], s8 offen nt
  s_addk_i32 s8, 4096
  v_dot2_f32_bf16 v226, v64, v232, 0
  v_dot2_f32_bf16 v226, v65, v233, v226
  v_dot2_f32_bf16 v226, v66, v234, v226
  v_dot2_f32_bf16 v226, v67, v235, v226
  s_waitcnt vmcnt(4)
  s_cmp_eq_u32 s12, 15
  s_cselect_b32 s44, s14, s44
  s_cselect_b32 s45, s15, s45
  s_cselect_b32 s8, s13, s8
  buffer_load_dwordx4 v[24:27], v2, s[44:47], s8 offen nt
  s_addk_i32 s8, 4096
  v_dot2_f32_bf16 v227, v68, v232, 0
  v_dot2_f32_bf16 v227, v69, v233, v227
  v_dot2_f32_bf16 v227, v70, v234, v227
  v_dot2_f32_bf16 v227, v71, v235, v227
  s_waitcnt vmcnt(4)
  buffer_load_dwordx4 v[28:31], v2, s[44:47], s8 offen nt
  s_addk_i32 s8, 4096
  v_dot2_f32_bf16 v228, v72, v232, 0
  v_dot2_f32_bf16 v228, v73, v233, v228
  v_dot2_f32_bf16 v228, v74, v234, v228
  v_dot2_f32_bf16 v228, v75, v235, v228
  s_waitcnt vmcnt(4)
  buffer_load_dwordx4 v[32:35], v2, s[44:47], s8 offen nt
  s_addk_i32 s8, 4096
  v_dot2_f32_bf16 v229, v76, v232, 0
  v_dot2_f32_bf16 v229, v77, v233, v229
  v_dot2_f32_bf16 v229, v78, v234, v229
  v_dot2_f32_bf16 v229, v79, v235, v229
  s_waitcnt vmcnt(4)
  buffer_load_dwordx4 v[36:39], v2, s[44:47], s8 offen nt
  s_addk_i32 s8, 4096
  v_dot2_f32_bf16 v230, v80, v232, 0
  v_dot2_f32_bf16 v230, v81, v233, v230
  v_dot2_f32_bf16 v230, v82, v234, v230
  v_dot2_f32_bf16 v230, v83, v235, v230
  s_waitcnt vmcnt(4)
  buffer_load_dwordx4 v[40:43], v2, s[44:47], s8 offen nt
  s_addk_i32 s8, 4096
  buffer_load_dwordx4 v[44:47], v2, s[44:47], s8 offen nt
  s_addk_i32 s8, 4096
  v_dot2_f32_bf16 v231, v84, v232, 0
  v_dot2_f32_bf16 v231, v85, v233, v231
  v_dot2_f32_bf16 v231, v86, v234, v231
  v_dot2_f32_bf16 v231, v87, v235, v231
  v_add_f32_dpp v216, v216, v216 row_ror:8 row_mask:0xf bank_mask:0x3
  s_nop 1
  v_add_f32_dpp v216, v224, v224 row_ror:8 row_mask:0xf bank_mask:0xc
  v_add_f32_dpp v217, v217, v217 row_ror:8 row_mask:0xf bank_mask:0x3
  s_nop 1
  v_add_f32_dpp v217, v225, v225 row_ror:8 row_mask:0xf bank_mask:0xc
  v_add_f32_dpp v218, v218, v218 row_ror:8 row_mask:0xf bank_mask:0x3
  s_nop 1
  v_add_f32_dpp v218, v226, v226 row_ror:8 row_mask:0xf bank_mask:0xc
  v_add_f32_dpp v219, v219, v219 row_ror:8 row_mask:0xf bank_mask:0x3
  s_nop 1
  v_add_f32_dpp v219, v227, v227 row_ror:8 row_mask:0xf bank_mask:0xc
  v_add_f32_dpp v220, v220, v220 row_ror:8 row_mask:0xf bank_mask:0x3
  s_nop 1
  v_add_f32_dpp v220, v228, v228 row_ror:8 row_mask:0xf bank_mask:0xc
  v_add_f32_dpp v221, v221, v221 row_ror:8 row_mask:0xf bank_mask:0x3
  s_nop 1
  v_add_f32_dpp v221, v229, v229 row_ror:8 row_mask:0xf bank_mask:0xc
  v_add_f32_dpp v222, v222, v222 row_ror:8 row_mask:0xf bank_mask:0x3
  s_nop 1
  v_add_f32_dpp v222, v230, v230 row_ror:8 row_mask:0xf bank_mask:0xc
  v_add_f32_dpp v223, v223, v223 row_ror:8 row_mask:0xf bank_mask:0x3
  s_nop 1
  v_add_f32_dpp v223, v231, v231 row_ror:8 row_mask:0xf bank_mask:0xc
  v_add_f32_dpp v216, v216, v216 row_shl:4 row_mask:0xf bank_mask:0x5
  s_nop 1
  v_add_f32_dpp v216, v220, v220 row_shr:4 row_mask:0xf bank_mask:0xa
  v_add_f32_dpp v217, v217, v217 row_shl:4 row_mask:0xf bank_mask:0x5
  s_nop 1
  v_add_f32_dpp v217, v221, v221 row_shr:4 row_mask:0xf bank_mask:0xa
  v_add_f32_dpp v218, v218, v218 row_shl:4 row_mask:0xf bank_mask:0x5
  s_nop 1
  v_add_f32_dpp v218, v222, v222 row_shr:4 row_mask:0xf bank_mask:0xa
  v_add_f32_dpp v219, v219, v219 row_shl:4 row_mask:0xf bank_mask:0x5
  s_nop 1
  v_add_f32_dpp v219, v223, v223 row_shr:4 row_mask:0xf bank_mask:0xa
  v_cndmask_b32 v16, v216, v218, s[94:95]
  v_cndmask_b32 v18, v218, v216, s[94:95]
  v_cndmask_b32 v17, v217, v219, s[94:95]
  v_cndmask_b32 v19, v219, v217, s[94:95]
  v_add_f32_dpp v16, v18, v16 quad_perm:[2,3,0,1] row_mask:0xf bank_mask:0xf
  s_nop 0
  v_add_f32_dpp v17, v19, v17 quad_perm:[2,3,0,1] row_mask:0xf bank_mask:0xf
  v_cndmask_b32 v20, v16, v17, s[96:97]
  v_cndmask_b32 v21, v17, v16, s[96:97]
  s_nop 1
  v_add_f32_dpp v20, v21, v20 quad_perm:[1,0,3,2] row_mask:0xf bank_mask:0xf
  ds_write_b32 v238, v20 offset:4096
  v_max_f32 v248, v248, v20
  v_add_u32 v238, 256, v238
  s_add_u32 s12, s12, 1
  s_cmp_lt_u32 s12, 16
  s_cbranch_scc1 L_kloop
  v_subrev_u32 v238, 4096, v238
  ds_read_b32 v237, v238 offset:4096
  v_max_f32_dpp v248, v248, v248 row_ror:8 row_mask:0xf bank_mask:0xf
  s_nop 1
  v_max_f32_dpp v248, v248, v248 row_ror:4 row_mask:0xf bank_mask:0xf
  s_nop 1
  v_max_f32_dpp v248, v248, v248 row_ror:2 row_mask:0xf bank_mask:0xf
  s_nop 1
  v_max_f32_dpp v248, v248, v248 row_ror:1 row_mask:0xf bank_mask:0xf
  v_mov_b32 v17, v248
  s_nop 1
  v_permlane16_swap_b32 v248, v17
  v_max_f32 v248, v248, v17
  v_mov_b32 v17, v248
  s_nop 1
  v_permlane32_swap_b32 v248, v17
  v_max_f32 v248, v248, v17
  s_mov_b32 s7, 0x3e0293ee
  v_mul_f32 v248, s7, v248
  s_waitcnt lgkmcnt(0)
  v_fma_f32 v236, v237, s7, -v248
  v_exp_f32 v236, v236
  s_mov_b32 s12, 0
  v_add_u32 v238, 256, v238
  ds_read_b32 v237, v238 offset:4096
  v_add_f32 v249, v249, v236
  s_waitcnt vmcnt(5)
  v_lshlrev_b32 v16, 16, v24
  v_and_b32 v17, s92, v24
  v_lshlrev_b32 v18, 16, v25
  v_and_b32 v19, s92, v25
  v_lshlrev_b32 v20, 16, v26
  v_and_b32 v21, s92, v26
  v_lshlrev_b32 v22, 16, v27
  v_and_b32 v23, s92, v27
  v_fmac_f32_dpp v240, v236, v16 row_newbcast:0 row_mask:0xf bank_mask:0xf
  v_fmac_f32_dpp v241, v236, v17 row_newbcast:0 row_mask:0xf bank_mask:0xf
  v_fmac_f32_dpp v242, v236, v18 row_newbcast:0 row_mask:0xf bank_mask:0xf
  v_fmac_f32_dpp v243, v236, v19 row_newbcast:0 row_mask:0xf bank_mask:0xf
  v_fmac_f32_dpp v244, v236, v20 row_newbcast:0 row_mask:0xf bank_mask:0xf
  v_fmac_f32_dpp v245, v236, v21 row_newbcast:0 row_mask:0xf bank_mask:0xf
  v_fmac_f32_dpp v246, v236, v22 row_newbcast:0 row_mask:0xf bank_mask:0xf
  v_fmac_f32_dpp v247, v236, v23 row_newbcast:0 row_mask:0xf bank_mask:0xf
  s_waitcnt vmcnt(4)
  buffer_load_dwordx4 v[48:51], v2, s[44:47], s8 offen nt
  s_addk_i32 s8, 4096
  v_lshlrev_b32 v16, 16, v28
  v_and_b32 v17, s92, v28
  v_lshlrev_b32 v18, 16, v29
  v_and_b32 v19, s92, v29
  v_lshlrev_b32 v20, 16, v30
  v_and_b32 v21, s92, v30
  v_lshlrev_b32 v22, 16, v31
  v_and_b32 v23, s92, v31
  v_fmac_f32_dpp v240, v236, v16 row_newbcast:1 row_mask:0xf bank_mask:0xf
  v_fmac_f32_dpp v241, v236, v17 row_newbcast:1 row_mask:0xf bank_mask:0xf
  v_fmac_f32_dpp v242, v236, v18 row_newbcast:1 row_mask:0xf bank_mask:0xf
  v_fmac_f32_dpp v243, v236, v19 row_newbcast:1 row_mask:0xf bank_mask:0xf
  v_fmac_f32_dpp v244, v236, v20 row_newbcast:1 row_mask:0xf bank_mask:0xf
  v_fmac_f32_dpp v245, v236, v21 row_newbcast:1 row_mask:0xf bank_mask:0xf
  v_fmac_f32_dpp v246, v236, v22 row_newbcast:1 row_mask:0xf bank_mask:0xf
  v_fmac_f32_dpp v247, v236, v23 row_newbcast:1 row_mask:0xf bank_mask:0xf
  s_waitcnt vmcnt(4)
  buffer_load_dwordx4 v[52:55], v2, s[44:47], s8 offen nt
  s_addk_i32 s8, 4096
  v_lshlrev_b32 v16, 16, v32
  v_and_b32 v17, s92, v32
  v_lshlrev_b32 v18, 16, v33
  v_and_b32 v19, s92, v33
  v_lshlrev_b32 v20, 16, v34
  v_and_b32 v21, s92, v34
  v_lshlrev_b32 v22, 16, v35
  v_and_b32 v23, s92, v35
  v_fmac_f32_dpp v240, v236, v16 row_newbcast:2 row_mask:0xf bank_mask:0xf
  v_fmac_f32_dpp v241, v236, v17 row_newbcast:2 row_mask:0xf bank_mask:0xf
  v_fmac_f32_dpp v242, v236, v18 row_newbcast:2 row_mask:0xf bank_mask:0xf
  v_fmac_f32_dpp v243, v236, v19 row_newbcast:2 row_mask:0xf bank_mask:0xf
  v_fmac_f32_dpp v244, v236, v20 row_newbcast:2 row_mask:0xf bank_mask:0xf
  v_fmac_f32_dpp v245, v236, v21 row_newbcast:2 row_mask:0xf bank_mask:0xf
  v_fmac_f32_dpp v246, v236, v22 row_newbcast:2 row_mask:0xf bank_mask:0xf
  v_fmac_f32_dpp v247, v236, v23 row_newbcast:2 row_mask:0xf bank_mask:0xf
  s_waitcnt vmcnt(4)
  buffer_load_dwordx4 v[56:59], v2, s[44:47], s8 offen nt
  s_addk_i32 s8, 4096
  v_lshlrev_b32 v16, 16, v36
  v_and_b32 v17, s92, v36
  v_lshlrev_b32 v18, 16, v37
  v_and_b32 v19, s92, v37
  v_lshlrev_b32 v20, 16, v38
  v_and_b32 v21, s92, v38
  v_lshlrev_b32 v22, 16, v39
  v_and_b32 v23, s92, v39
  v_fmac_f32_dpp v240, v236, v16 row_newbcast:3 row_mask:0xf bank_mask:0xf
  v_fmac_f32_dpp v241, v236, v17 row_newbcast:3 row_mask:0xf bank_mask:0xf
  v_fmac_f32_dpp v242, v236, v18 row_newbcast:3 row_mask:0xf bank_mask:0xf
  v_fmac_f32_dpp v243, v236, v19 row_newbcast:3 row_mask:0xf bank_mask:0xf
  v_fmac_f32_dpp v244, v236, v20 row_newbcast:3 row_mask:0xf bank_mask:0xf
  v_fmac_f32_dpp v245, v236, v21 row_newbcast:3 row_mask:0xf bank_mask:0xf
  v_fmac_f32_dpp v246, v236, v22 row_newbcast:3 row_mask:0xf bank_mask:0xf
  v_fmac_f32_dpp v247, v236, v23 row_newbcast:3 row_mask:0xf bank_mask:0xf
  s_waitcnt vmcnt(4)
  buffer_load_dwordx4 v[60:63], v2, s[44:47], s8 offen nt
  s_addk_i32 s8, 4096
  v_lshlrev_b32 v16, 16, v40
  v_and_b32 v17, s92, v40
  v_lshlrev_b32 v18, 16, v41
  v_and_b32 v19, s92, v41
  v_lshlrev_b32 v20, 16, v42
  v_and_b32 v21, s92, v42
  v_lshlrev_b32 v22, 16, v43
  v_and_b32 v23, s92, v43
  v_fmac_f32_dpp v240, v236, v16 row_newbcast:4 row_mask:0xf bank_mask:0xf
  v_fmac_f32_dpp v241, v236, v17 row_newbcast:4 row_mask:0xf bank_mask:0xf
  v_fmac_f32_dpp v242, v236, v18 row_newbcast:4 row_mask:0xf bank_mask:0xf
  v_fmac_f32_dpp v243, v236, v19 row_newbcast:4 row_mask:0xf bank_mask:0xf
  v_fmac_f32_dpp v244, v236, v20 row_newbcast:4 row_mask:0xf bank_mask:0xf
  v_fmac_f32_dpp v245, v236, v21 row_newbcast:4 row_mask:0xf bank_mask:0xf
  v_fmac_f32_dpp v246, v236, v22 row_newbcast:4 row_mask:0xf bank_mask:0xf
  v_fmac_f32_dpp v247, v236, v23 row_newbcast:4 row_mask:0xf bank_mask:0xf
  s_waitcnt vmcnt(4)
  buffer_load_dwordx4 v[64:67], v2, s[44:47], s8 offen nt
  s_addk_i32 s8, 4096
  v_lshlrev_b32 v16, 16, v44
  v_and_b32 v17, s92, v44
  v_lshlrev_b32 v18, 16, v45
  v_and_b32 v19, s92, v45
  v_lshlrev_b32 v20, 16, v46
  v_and_b32 v21, s92, v46
  v_lshlrev_b32 v22, 16, v47
  v_and_b32 v23, s92, v47
  v_fmac_f32_dpp v240, v236, v16 row_newbcast:5 row_mask:0xf bank_mask:0xf
  v_fmac_f32_dpp v241, v236, v17 row_newbcast:5 row_mask:0xf bank_mask:0xf
  v_fmac_f32_dpp v242, v236, v18 row_newbcast:5 row_mask:0xf bank_mask:0xf
  v_fmac_f32_dpp v243, v236, v19 row_newbcast:5 row_mask:0xf bank_mask:0xf
  v_fmac_f32_dpp v244, v236, v20 row_newbcast:5 row_mask:0xf bank_mask:0xf
  v_fmac_f32_dpp v245, v236, v21 row_newbcast:5 row_mask:0xf bank_mask:0xf
  v_fmac_f32_dpp v246, v236, v22 row_newbcast:5 row_mask:0xf bank_mask:0xf
  v_fmac_f32_dpp v247, v236, v23 row_newbcast:5 row_mask:0xf bank_mask:0xf
  s_waitcnt vmcnt(4)
  buffer_load_dwordx4 v[68:71], v2, s[44:47], s8 offen nt
  s_addk_i32 s8, 4096
  v_lshlrev_b32 v16, 16, v48
  v_and_b32 v17, s92, v48
  v_lshlrev_b32 v18, 16, v49
  v_and_b32 v19, s92, v49
  v_lshlrev_b32 v20, 16, v50
  v_and_b32 v21, s92, v50
  v_lshlrev_b32 v22, 16, v51
  v_and_b32 v23, s92, v51
  v_fmac_f32_dpp v240, v236, v16 row_newbcast:6 row_mask:0xf bank_mask:0xf
  v_fmac_f32_dpp v241, v236, v17 row_newbcast:6 row_mask:0xf bank_mask:0xf
  v_fmac_f32_dpp v242, v236, v18 row_newbcast:6 row_mask:0xf bank_mask:0xf
  v_fmac_f32_dpp v243, v236, v19 row_newbcast:6 row_mask:0xf bank_mask:0xf
  v_fmac_f32_dpp v244, v236, v20 row_newbcast:6 row_mask:0xf bank_mask:0xf
  v_fmac_f32_dpp v245, v236, v21 row_newbcast:6 row_mask:0xf bank_mask:0xf
  v_fmac_f32_dpp v246, v236, v22 row_newbcast:6 row_mask:0xf bank_mask:0xf
  v_fmac_f32_dpp v247, v236, v23 row_newbcast:6 row_mask:0xf bank_mask:0xf
  s_waitcnt vmcnt(4)
  buffer_load_dwordx4 v[72:75], v2, s[44:47], s8 offen nt
  s_addk_i32 s8, 4096
  v_lshlrev_b32 v16, 16, v52
  v_and_b32 v17, s92, v52
  v_lshlrev_b32 v18, 16, v53
  v_and_b32 v19, s92, v53
  v_lshlrev_b32 v20, 16, v54
  v_and_b32 v21, s92, v54
  v_lshlrev_b32 v22, 16, v55
  v_and_b32 v23, s92, v55
  v_fmac_f32_dpp v240, v236, v16 row_newbcast:7 row_mask:0xf bank_mask:0xf
  v_fmac_f32_dpp v241, v236, v17 row_newbcast:7 row_mask:0xf bank_mask:0xf
  v_fmac_f32_dpp v242, v236, v18 row_newbcast:7 row_mask:0xf bank_mask:0xf
  v_fmac_f32_dpp v243, v236, v19 row_newbcast:7 row_mask:0xf bank_mask:0xf
  v_fmac_f32_dpp v244, v236, v20 row_newbcast:7 row_mask:0xf bank_mask:0xf
  v_fmac_f32_dpp v245, v236, v21 row_newbcast:7 row_mask:0xf bank_mask:0xf
  v_fmac_f32_dpp v246, v236, v22 row_newbcast:7 row_mask:0xf bank_mask:0xf
  v_fmac_f32_dpp v247, v236, v23 row_newbcast:7 row_mask:0xf bank_mask:0xf
  s_waitcnt vmcnt(4)
  buffer_load_dwordx4 v[76:79], v2, s[44:47], s8 offen nt
  s_addk_i32 s8, 4096
  v_lshlrev_b32 v16, 16, v56
  v_and_b32 v17, s92, v56
  v_lshlrev_b32 v18, 16, v57
  v_and_b32 v19, s92, v57
  v_lshlrev_b32 v20, 16, v58
  v_and_b32 v21, s92, v58
  v_lshlrev_b32 v22, 16, v59
  v_and_b32 v23, s92, v59
  v_fmac_f32_dpp v240, v236, v16 row_newbcast:8 row_mask:0xf bank_mask:0xf
  v_fmac_f32_dpp v241, v236, v17 row_newbcast:8 row_mask:0xf bank_mask:0xf
  v_fmac_f32_dpp v242, v236, v18 row_newbcast:8 row_mask:0xf bank_mask:0xf
  v_fmac_f32_dpp v243, v236, v19 row_newbcast:8 row_mask:0xf bank_mask:0xf
  v_fmac_f32_dpp v244, v236, v20 row_newbcast:8 row_mask:0xf bank_mask:0xf
  v_fmac_f32_dpp v245, v236, v21 row_newbcast:8 row_mask:0xf bank_mask:0xf
  v_fmac_f32_dpp v246, v236, v22 row_newbcast:8 row_mask:0xf bank_mask:0xf
  v_fmac_f32_dpp v247, v236, v23 row_newbcast:8 row_mask:0xf bank_mask:0xf
  s_waitcnt lgkmcnt(0)
  v_fma_f32 v237, v237, s7, -v248
  v_exp_f32 v237, v237
  s_waitcnt vmcnt(4)
  buffer_load_dwordx4 v[80:83], v2, s[44:47], s8 offen nt
  s_addk_i32 s8, 4096
  v_lshlrev_b32 v16, 16, v60
  v_and_b32 v17, s92, v60
  v_lshlrev_b32 v18, 16, v61
  v_and_b32 v19, s92, v61
  v_lshlrev_b32 v20, 16, v62
  v_and_b32 v21, s92, v62
  v_lshlrev_b32 v22, 16, v63
  v_and_b32 v23, s92, v63
  v_fmac_f32_dpp v240, v236, v16 row_newbcast:9 row_mask:0xf bank_mask:0xf
  v_fmac_f32_dpp v241, v236, v17 row_newbcast:9 row_mask:0xf bank_mask:0xf
  v_fmac_f32_dpp v242, v236, v18 row_newbcast:9 row_mask:0xf bank_mask:0xf
  v_fmac_f32_dpp v243, v236, v19 row_newbcast:9 row_mask:0xf bank_mask:0xf
  v_fmac_f32_dpp v244, v236, v20 row_newbcast:9 row_mask:0xf bank_mask:0xf
  v_fmac_f32_dpp v245, v236, v21 row_newbcast:9 row_mask:0xf bank_mask:0xf
  v_fmac_f32_dpp v246, v236, v22 row_newbcast:9 row_mask:0xf bank_mask:0xf
  v_fmac_f32_dpp v247, v236, v23 row_newbcast:9 row_mask:0xf bank_mask:0xf
  s_waitcnt vmcnt(4)
  buffer_load_dwordx4 v[84:87], v2, s[44:47], s8 offen nt
  s_addk_i32 s8, 4096
  v_lshlrev_b32 v16, 16, v64
  v_and_b32 v17, s92, v64
  v_lshlrev_b32 v18, 16, v65
  v_and_b32 v19, s92, v65
  v_lshlrev_b32 v20, 16, v66
  v_and_b32 v21, s92, v66
  v_lshlrev_b32 v22, 16, v67
  v_and_b32 v23, s92, v67
  v_fmac_f32_dpp v240, v236, v16 row_newbcast:10 row_mask:0xf bank_mask:0xf
  v_fmac_f32_dpp v241, v236, v17 row_newbcast:10 row_mask:0xf bank_mask:0xf
  v_fmac_f32_dpp v242, v236, v18 row_newbcast:10 row_mask:0xf bank_mask:0xf
  v_fmac_f32_dpp v243, v236, v19 row_newbcast:10 row_mask:0xf bank_mask:0xf
  v_fmac_f32_dpp v244, v236, v20 row_newbcast:10 row_mask:0xf bank_mask:0xf
  v_fmac_f32_dpp v245, v236, v21 row_newbcast:10 row_mask:0xf bank_mask:0xf
  v_fmac_f32_dpp v246, v236, v22 row_newbcast:10 row_mask:0xf bank_mask:0xf
  v_fmac_f32_dpp v247, v236, v23 row_newbcast:10 row_mask:0xf bank_mask:0xf
  s_waitcnt vmcnt(4)
  buffer_load_dwordx4 v[24:27], v2, s[44:47], s8 offen nt
  s_addk_i32 s8, 4096
  v_lshlrev_b32 v16, 16, v68
  v_and_b32 v17, s92, v68
  v_lshlrev_b32 v18, 16, v69
  v_and_b32 v19, s92, v69
  v_lshlrev_b32 v20, 16, v70
  v_and_b32 v21, s92, v70
  v_lshlrev_b32 v22, 16, v71
  v_and_b32 v23, s92, v71
  v_fmac_f32_dpp v240, v236, v16 row_newbcast:11 row_mask:0xf bank_mask:0xf
  v_fmac_f32_dpp v241, v236, v17 row_newbcast:11 row_mask:0xf bank_mask:0xf
  v_fmac_f32_dpp v242, v236, v18 row_newbcast:11 row_mask:0xf bank_mask:0xf
  v_fmac_f32_dpp v243, v236, v19 row_newbcast:11 row_mask:0xf bank_mask:0xf
  v_fmac_f32_dpp v244, v236, v20 row_newbcast:11 row_mask:0xf bank_mask:0xf
  v_fmac_f32_dpp v245, v236, v21 row_newbcast:11 row_mask:0xf bank_mask:0xf
  v_fmac_f32_dpp v246, v236, v22 row_newbcast:11 row_mask:0xf bank_mask:0xf
  v_fmac_f32_dpp v247, v236, v23 row_newbcast:11 row_mask:0xf bank_mask:0xf
  s_waitcnt vmcnt(4)
  buffer_load_dwordx4 v[28:31], v2, s[44:47], s8 offen nt
  s_addk_i32 s8, 4096
  v_lshlrev_b32 v16, 16, v72
  v_and_b32 v17, s92, v72
  v_lshlrev_b32 v18, 16, v73
  v_and_b32 v19, s92, v73
  v_lshlrev_b32 v20, 16, v74
  v_and_b32 v21, s92, v74
  v_lshlrev_b32 v22, 16, v75
  v_and_b32 v23, s92, v75
  v_fmac_f32_dpp v240, v236, v16 row_newbcast:12 row_mask:0xf bank_mask:0xf
  v_fmac_f32_dpp v241, v236, v17 row_newbcast:12 row_mask:0xf bank_mask:0xf
  v_fmac_f32_dpp v242, v236, v18 row_newbcast:12 row_mask:0xf bank_mask:0xf
  v_fmac_f32_dpp v243, v236, v19 row_newbcast:12 row_mask:0xf bank_mask:0xf
  v_fmac_f32_dpp v244, v236, v20 row_newbcast:12 row_mask:0xf bank_mask:0xf
  v_fmac_f32_dpp v245, v236, v21 row_newbcast:12 row_mask:0xf bank_mask:0xf
  v_fmac_f32_dpp v246, v236, v22 row_newbcast:12 row_mask:0xf bank_mask:0xf
  v_fmac_f32_dpp v247, v236, v23 row_newbcast:12 row_mask:0xf bank_mask:0xf
  s_waitcnt vmcnt(4)
  buffer_load_dwordx4 v[32:35], v2, s[44:47], s8 offen nt
  s_addk_i32 s8, 4096
  v_lshlrev_b32 v16, 16, v76
  v_and_b32 v17, s92, v76
  v_lshlrev_b32 v18, 16, v77
  v_and_b32 v19, s92, v77
  v_lshlrev_b32 v20, 16, v78
  v_and_b32 v21, s92, v78
  v_lshlrev_b32 v22, 16, v79
  v_and_b32 v23, s92, v79
  v_fmac_f32_dpp v240, v236, v16 row_newbcast:13 row_mask:0xf bank_mask:0xf
  v_fmac_f32_dpp v241, v236, v17 row_newbcast:13 row_mask:0xf bank_mask:0xf
  v_fmac_f32_dpp v242, v236, v18 row_newbcast:13 row_mask:0xf bank_mask:0xf
  v_fmac_f32_dpp v243, v236, v19 row_newbcast:13 row_mask:0xf bank_mask:0xf
  v_fmac_f32_dpp v244, v236, v20 row_newbcast:13 row_mask:0xf bank_mask:0xf
  v_fmac_f32_dpp v245, v236, v21 row_newbcast:13 row_mask:0xf bank_mask:0xf
  v_fmac_f32_dpp v246, v236, v22 row_newbcast:13 row_mask:0xf bank_mask:0xf
  v_fmac_f32_dpp v247, v236, v23 row_newbcast:13 row_mask:0xf bank_mask:0xf
  s_waitcnt vmcnt(4)
  buffer_load_dwordx4 v[36:39], v2, s[44:47], s8 offen nt
  s_addk_i32 s8, 4096
  v_lshlrev_b32 v16, 16, v80
  v_and_b32 v17, s92, v80
  v_lshlrev_b32 v18, 16, v81
  v_and_b32 v19, s92, v81
  v_lshlrev_b32 v20, 16, v82
  v_and_b32 v21, s92, v82
  v_lshlrev_b32 v22, 16, v83
  v_and_b32 v23, s92, v83
  v_fmac_f32_dpp v240, v236, v16 row_newbcast:14 row_mask:0xf bank_mask:0xf
  v_fmac_f32_dpp v241, v236, v17 row_newbcast:14 row_mask:0xf bank_mask:0xf
  v_fmac_f32_dpp v242, v236, v18 row_newbcast:14 row_mask:0xf bank_mask:0xf
  v_fmac_f32_dpp v243, v236, v19 row_newbcast:14 row_mask:0xf bank_mask:0xf
  v_fmac_f32_dpp v244, v236, v20 row_newbcast:14 row_mask:0xf bank_mask:0xf
  v_fmac_f32_dpp v245, v236, v21 row_newbcast:14 row_mask:0xf bank_mask:0xf
  v_fmac_f32_dpp v246, v236, v22 row_newbcast:14 row_mask:0xf bank_mask:0xf
  v_fmac_f32_dpp v247, v236, v23 row_newbcast:14 row_mask:0xf bank_mask:0xf
  s_waitcnt vmcnt(4)
  buffer_load_dwordx4 v[40:43], v2, s[44:47], s8 offen nt
  s_addk_i32 s8, 4096
  v_lshlrev_b32 v16, 16, v84
  v_and_b32 v17, s92, v84
  v_lshlrev_b32 v18, 16, v85
  v_and_b32 v19, s92, v85
  v_lshlrev_b32 v20, 16, v86
  v_and_b32 v21, s92, v86
  v_lshlrev_b32 v22, 16, v87
  v_and_b32 v23, s92, v87
  v_fmac_f32_dpp v240, v236, v16 row_newbcast:15 row_mask:0xf bank_mask:0xf
  v_fmac_f32_dpp v241, v236, v17 row_newbcast:15 row_mask:0xf bank_mask:0xf
  v_fmac_f32_dpp v242, v236, v18 row_newbcast:15 row_mask:0xf bank_mask:0xf
  v_fmac_f32_dpp v243, v236, v19 row_newbcast:15 row_mask:0xf bank_mask:0xf
  v_fmac_f32_dpp v244, v236, v20 row_newbcast:15 row_mask:0xf bank_mask:0xf
  v_fmac_f32_dpp v245, v236, v21 row_newbcast:15 row_mask:0xf bank_mask:0xf
  v_fmac_f32_dpp v246, v236, v22 row_newbcast:15 row_mask:0xf bank_mask:0xf
  v_fmac_f32_dpp v247, v236, v23 row_newbcast:15 row_mask:0xf bank_mask:0xf
  v_mov_b32 v236, v237
  s_add_u32 s12, s12, 1
L_vloopA:
  v_add_u32 v238, 256, v238
  ds_read_b32 v237, v238 offset:4096
  v_add_f32 v249, v249, v236
  s_waitcnt vmcnt(4)
  buffer_load_dwordx4 v[44:47], v2, s[44:47], s8 offen nt
  s_addk_i32 s8, 4096
  v_lshlrev_b32 v16, 16, v24
  v_and_b32 v17, s92, v24
  v_lshlrev_b32 v18, 16, v25
  v_and_b32 v19, s92, v25
  v_lshlrev_b32 v20, 16, v26
  v_and_b32 v21, s92, v26
  v_lshlrev_b32 v22, 16, v27
  v_and_b32 v23, s92, v27
  v_fmac_f32_dpp v240, v236, v16 row_newbcast:0 row_mask:0xf bank_mask:0xf
  v_fmac_f32_dpp v241, v236, v17 row_newbcast:0 row_mask:0xf bank_mask:0xf
  v_fmac_f32_dpp v242, v236, v18 row_newbcast:0 row_mask:0xf bank_mask:0xf
  v_fmac_f32_dpp v243, v236, v19 row_newbcast:0 row_mask:0xf bank_mask:0xf
  v_fmac_f32_dpp v244, v236, v20 row_newbcast:0 row_mask:0xf bank_mask:0xf
  v_fmac_f32_dpp v245, v236, v21 row_newbcast:0 row_mask:0xf bank_mask:0xf
  v_fmac_f32_dpp v246, v236, v22 row_newbcast:0 row_mask:0xf bank_mask:0xf
  v_fmac_f32_dpp v247, v236, v23 row_newbcast:0 row_mask:0xf bank_mask:0xf
  s_waitcnt vmcnt(4)
  buffer_load_dwordx4 v[48:51], v2, s[44:47], s8 offen nt
  s_addk_i32 s8, 4096
  v_lshlrev_b32 v16, 16, v28
  v_and_b32 v17, s92, v28
  v_lshlrev_b32 v18, 16, v29
  v_and_b32 v19, s92, v29
  v_lshlrev_b32 v20, 16, v30
  v_and_b32 v21, s92, v30
  v_lshlrev_b32 v22, 16, v31
  v_and_b32 v23, s92, v31
  v_fmac_f32_dpp v240, v236, v16 row_newbcast:1 row_mask:0xf bank_mask:0xf
  v_fmac_f32_dpp v241, v236, v17 row_newbcast:1 row_mask:0xf bank_mask:0xf
  v_fmac_f32_dpp v242, v236, v18 row_newbcast:1 row_mask:0xf bank_mask:0xf
  v_fmac_f32_dpp v243, v236, v19 row_newbcast:1 row_mask:0xf bank_mask:0xf
  v_fmac_f32_dpp v244, v236, v20 row_newbcast:1 row_mask:0xf bank_mask:0xf
  v_fmac_f32_dpp v245, v236, v21 row_newbcast:1 row_mask:0xf bank_mask:0xf
  v_fmac_f32_dpp v246, v236, v22 row_newbcast:1 row_mask:0xf bank_mask:0xf
  v_fmac_f32_dpp v247, v236, v23 row_newbcast:1 row_mask:0xf bank_mask:0xf
  s_waitcnt vmcnt(4)
  buffer_load_dwordx4 v[52:55], v2, s[44:47], s8 offen nt
  s_addk_i32 s8, 4096
  v_lshlrev_b32 v16, 16, v32
  v_and_b32 v17, s92, v32
  v_lshlrev_b32 v18, 16, v33
  v_and_b32 v19, s92, v33
  v_lshlrev_b32 v20, 16, v34
  v_and_b32 v21, s92, v34
  v_lshlrev_b32 v22, 16, v35
  v_and_b32 v23, s92, v35
  v_fmac_f32_dpp v240, v236, v16 row_newbcast:2 row_mask:0xf bank_mask:0xf
  v_fmac_f32_dpp v241, v236, v17 row_newbcast:2 row_mask:0xf bank_mask:0xf
  v_fmac_f32_dpp v242, v236, v18 row_newbcast:2 row_mask:0xf bank_mask:0xf
  v_fmac_f32_dpp v243, v236, v19 row_newbcast:2 row_mask:0xf bank_mask:0xf
  v_fmac_f32_dpp v244, v236, v20 row_newbcast:2 row_mask:0xf bank_mask:0xf
  v_fmac_f32_dpp v245, v236, v21 row_newbcast:2 row_mask:0xf bank_mask:0xf
  v_fmac_f32_dpp v246, v236, v22 row_newbcast:2 row_mask:0xf bank_mask:0xf
  v_fmac_f32_dpp v247, v236, v23 row_newbcast:2 row_mask:0xf bank_mask:0xf
  s_waitcnt vmcnt(4)
  buffer_load_dwordx4 v[56:59], v2, s[44:47], s8 offen nt
  s_addk_i32 s8, 4096
  v_lshlrev_b32 v16, 16, v36
  v_and_b32 v17, s92, v36
  v_lshlrev_b32 v18, 16, v37
  v_and_b32 v19, s92, v37
  v_lshlrev_b32 v20, 16, v38
  v_and_b32 v21, s92, v38
  v_lshlrev_b32 v22, 16, v39
  v_and_b32 v23, s92, v39
  v_fmac_f32_dpp v240, v236, v16 row_newbcast:3 row_mask:0xf bank_mask:0xf
  v_fmac_f32_dpp v241, v236, v17 row_newbcast:3 row_mask:0xf bank_mask:0xf
  v_fmac_f32_dpp v242, v236, v18 row_newbcast:3 row_mask:0xf bank_mask:0xf
  v_fmac_f32_dpp v243, v236, v19 row_newbcast:3 row_mask:0xf bank_mask:0xf
  v_fmac_f32_dpp v244, v236, v20 row_newbcast:3 row_mask:0xf bank_mask:0xf
  v_fmac_f32_dpp v245, v236, v21 row_newbcast:3 row_mask:0xf bank_mask:0xf
  v_fmac_f32_dpp v246, v236, v22 row_newbcast:3 row_mask:0xf bank_mask:0xf
  v_fmac_f32_dpp v247, v236, v23 row_newbcast:3 row_mask:0xf bank_mask:0xf
  s_waitcnt vmcnt(4)
  buffer_load_dwordx4 v[60:63], v2, s[44:47], s8 offen nt
  s_addk_i32 s8, 4096
  v_lshlrev_b32 v16, 16, v40
  v_and_b32 v17, s92, v40
  v_lshlrev_b32 v18, 16, v41
  v_and_b32 v19, s92, v41
  v_lshlrev_b32 v20, 16, v42
  v_and_b32 v21, s92, v42
  v_lshlrev_b32 v22, 16, v43
  v_and_b32 v23, s92, v43
  v_fmac_f32_dpp v240, v236, v16 row_newbcast:4 row_mask:0xf bank_mask:0xf
  v_fmac_f32_dpp v241, v236, v17 row_newbcast:4 row_mask:0xf bank_mask:0xf
  v_fmac_f32_dpp v242, v236, v18 row_newbcast:4 row_mask:0xf bank_mask:0xf
  v_fmac_f32_dpp v243, v236, v19 row_newbcast:4 row_mask:0xf bank_mask:0xf
  v_fmac_f32_dpp v244, v236, v20 row_newbcast:4 row_mask:0xf bank_mask:0xf
  v_fmac_f32_dpp v245, v236, v21 row_newbcast:4 row_mask:0xf bank_mask:0xf
  v_fmac_f32_dpp v246, v236, v22 row_newbcast:4 row_mask:0xf bank_mask:0xf
  v_fmac_f32_dpp v247, v236, v23 row_newbcast:4 row_mask:0xf bank_mask:0xf
  s_waitcnt vmcnt(4)
  buffer_load_dwordx4 v[64:67], v2, s[44:47], s8 offen nt
  s_addk_i32 s8, 4096
  v_lshlrev_b32 v16, 16, v44
  v_and_b32 v17, s92, v44
  v_lshlrev_b32 v18, 16, v45
  v_and_b32 v19, s92, v45
  v_lshlrev_b32 v20, 16, v46
  v_and_b32 v21, s92, v46
  v_lshlrev_b32 v22, 16, v47
  v_and_b32 v23, s92, v47
  v_fmac_f32_dpp v240, v236, v16 row_newbcast:5 row_mask:0xf bank_mask:0xf
  v_fmac_f32_dpp v241, v236, v17 row_newbcast:5 row_mask:0xf bank_mask:0xf
  v_fmac_f32_dpp v242, v236, v18 row_newbcast:5 row_mask:0xf bank_mask:0xf
  v_fmac_f32_dpp v243, v236, v19 row_newbcast:5 row_mask:0xf bank_mask:0xf
  v_fmac_f32_dpp v244, v236, v20 row_newbcast:5 row_mask:0xf bank_mask:0xf
  v_fmac_f32_dpp v245, v236, v21 row_newbcast:5 row_mask:0xf bank_mask:0xf
  v_fmac_f32_dpp v246, v236, v22 row_newbcast:5 row_mask:0xf bank_mask:0xf
  v_fmac_f32_dpp v247, v236, v23 row_newbcast:5 row_mask:0xf bank_mask:0xf
  s_waitcnt vmcnt(4)
  buffer_load_dwordx4 v[68:71], v2, s[44:47], s8 offen nt
  s_addk_i32 s8, 4096
  v_lshlrev_b32 v16, 16, v48
  v_and_b32 v17, s92, v48
  v_lshlrev_b32 v18, 16, v49
  v_and_b32 v19, s92, v49
  v_lshlrev_b32 v20, 16, v50
  v_and_b32 v21, s92, v50
  v_lshlrev_b32 v22, 16, v51
  v_and_b32 v23, s92, v51
  v_fmac_f32_dpp v240, v236, v16 row_newbcast:6 row_mask:0xf bank_mask:0xf
  v_fmac_f32_dpp v241, v236, v17 row_newbcast:6 row_mask:0xf bank_mask:0xf
  v_fmac_f32_dpp v242, v236, v18 row_newbcast:6 row_mask:0xf bank_mask:0xf
  v_fmac_f32_dpp v243, v236, v19 row_newbcast:6 row_mask:0xf bank_mask:0xf
  v_fmac_f32_dpp v244, v236, v20 row_newbcast:6 row_mask:0xf bank_mask:0xf
  v_fmac_f32_dpp v245, v236, v21 row_newbcast:6 row_mask:0xf bank_mask:0xf
  v_fmac_f32_dpp v246, v236, v22 row_newbcast:6 row_mask:0xf bank_mask:0xf
  v_fmac_f32_dpp v247, v236, v23 row_newbcast:6 row_mask:0xf bank_mask:0xf
  s_waitcnt vmcnt(4)
  buffer_load_dwordx4 v[72:75], v2, s[44:47], s8 offen nt
  s_addk_i32 s8, 4096
  v_lshlrev_b32 v16, 16, v52
  v_and_b32 v17, s92, v52
  v_lshlrev_b32 v18, 16, v53
  v_and_b32 v19, s92, v53
  v_lshlrev_b32 v20, 16, v54
  v_and_b32 v21, s92, v54
  v_lshlrev_b32 v22, 16, v55
  v_and_b32 v23, s92, v55
  v_fmac_f32_dpp v240, v236, v16 row_newbcast:7 row_mask:0xf bank_mask:0xf
  v_fmac_f32_dpp v241, v236, v17 row_newbcast:7 row_mask:0xf bank_mask:0xf
  v_fmac_f32_dpp v242, v236, v18 row_newbcast:7 row_mask:0xf bank_mask:0xf
  v_fmac_f32_dpp v243, v236, v19 row_newbcast:7 row_mask:0xf bank_mask:0xf
  v_fmac_f32_dpp v244, v236, v20 row_newbcast:7 row_mask:0xf bank_mask:0xf
  v_fmac_f32_dpp v245, v236, v21 row_newbcast:7 row_mask:0xf bank_mask:0xf
  v_fmac_f32_dpp v246, v236, v22 row_newbcast:7 row_mask:0xf bank_mask:0xf
  v_fmac_f32_dpp v247, v236, v23 row_newbcast:7 row_mask:0xf bank_mask:0xf
  s_waitcnt vmcnt(4)
  buffer_load_dwordx4 v[76:79], v2, s[44:47], s8 offen nt
  s_addk_i32 s8, 4096
  v_lshlrev_b32 v16, 16, v56
  v_and_b32 v17, s92, v56
  v_lshlrev_b32 v18, 16, v57
  v_and_b32 v19, s92, v57
  v_lshlrev_b32 v20, 16, v58
  v_and_b32 v21, s92, v58
  v_lshlrev_b32 v22, 16, v59
  v_and_b32 v23, s92, v59
  v_fmac_f32_dpp v240, v236, v16 row_newbcast:8 row_mask:0xf bank_mask:0xf
  v_fmac_f32_dpp v241, v236, v17 row_newbcast:8 row_mask:0xf bank_mask:0xf
  v_fmac_f32_dpp v242, v236, v18 row_newbcast:8 row_mask:0xf bank_mask:0xf
  v_fmac_f32_dpp v243, v236, v19 row_newbcast:8 row_mask:0xf bank_mask:0xf
  v_fmac_f32_dpp v244, v236, v20 row_newbcast:8 row_mask:0xf bank_mask:0xf
  v_fmac_f32_dpp v245, v236, v21 row_newbcast:8 row_mask:0xf bank_mask:0xf
  v_fmac_f32_dpp v246, v236, v22 row_newbcast:8 row_mask:0xf bank_mask:0xf
  v_fmac_f32_dpp v247, v236, v23 row_newbcast:8 row_mask:0xf bank_mask:0xf
  s_waitcnt lgkmcnt(0)
  v_fma_f32 v237, v237, s7, -v248
  v_exp_f32 v237, v237
  s_waitcnt vmcnt(4)
  buffer_load_dwordx4 v[80:83], v2, s[44:47], s8 offen nt
  s_addk_i32 s8, 4096
  v_lshlrev_b32 v16, 16, v60
  v_and_b32 v17, s92, v60
  v_lshlrev_b32 v18, 16, v61
  v_and_b32 v19, s92, v61
  v_lshlrev_b32 v20, 16, v62
  v_and_b32 v21, s92, v62
  v_lshlrev_b32 v22, 16, v63
  v_and_b32 v23, s92, v63
  v_fmac_f32_dpp v240, v236, v16 row_newbcast:9 row_mask:0xf bank_mask:0xf
  v_fmac_f32_dpp v241, v236, v17 row_newbcast:9 row_mask:0xf bank_mask:0xf
  v_fmac_f32_dpp v242, v236, v18 row_newbcast:9 row_mask:0xf bank_mask:0xf
  v_fmac_f32_dpp v243, v236, v19 row_newbcast:9 row_mask:0xf bank_mask:0xf
  v_fmac_f32_dpp v244, v236, v20 row_newbcast:9 row_mask:0xf bank_mask:0xf
  v_fmac_f32_dpp v245, v236, v21 row_newbcast:9 row_mask:0xf bank_mask:0xf
  v_fmac_f32_dpp v246, v236, v22 row_newbcast:9 row_mask:0xf bank_mask:0xf
  v_fmac_f32_dpp v247, v236, v23 row_newbcast:9 row_mask:0xf bank_mask:0xf
  s_waitcnt vmcnt(4)
  buffer_load_dwordx4 v[84:87], v2, s[44:47], s8 offen nt
  s_addk_i32 s8, 4096
  v_lshlrev_b32 v16, 16, v64
  v_and_b32 v17, s92, v64
  v_lshlrev_b32 v18, 16, v65
  v_and_b32 v19, s92, v65
  v_lshlrev_b32 v20, 16, v66
  v_and_b32 v21, s92, v66
  v_lshlrev_b32 v22, 16, v67
  v_and_b32 v23, s92, v67
  v_fmac_f32_dpp v240, v236, v16 row_newbcast:10 row_mask:0xf bank_mask:0xf
  v_fmac_f32_dpp v241, v236, v17 row_newbcast:10 row_mask:0xf bank_mask:0xf
  v_fmac_f32_dpp v242, v236, v18 row_newbcast:10 row_mask:0xf bank_mask:0xf
  v_fmac_f32_dpp v243, v236, v19 row_newbcast:10 row_mask:0xf bank_mask:0xf
  v_fmac_f32_dpp v244, v236, v20 row_newbcast:10 row_mask:0xf bank_mask:0xf
  v_fmac_f32_dpp v245, v236, v21 row_newbcast:10 row_mask:0xf bank_mask:0xf
  v_fmac_f32_dpp v246, v236, v22 row_newbcast:10 row_mask:0xf bank_mask:0xf
  v_fmac_f32_dpp v247, v236, v23 row_newbcast:10 row_mask:0xf bank_mask:0xf
  s_waitcnt vmcnt(4)
  buffer_load_dwordx4 v[24:27], v2, s[44:47], s8 offen nt
  s_addk_i32 s8, 4096
  v_lshlrev_b32 v16, 16, v68
  v_and_b32 v17, s92, v68
  v_lshlrev_b32 v18, 16, v69
  v_and_b32 v19, s92, v69
  v_lshlrev_b32 v20, 16, v70
  v_and_b32 v21, s92, v70
  v_lshlrev_b32 v22, 16, v71
  v_and_b32 v23, s92, v71
  v_fmac_f32_dpp v240, v236, v16 row_newbcast:11 row_mask:0xf bank_mask:0xf
  v_fmac_f32_dpp v241, v236, v17 row_newbcast:11 row_mask:0xf bank_mask:0xf
  v_fmac_f32_dpp v242, v236, v18 row_newbcast:11 row_mask:0xf bank_mask:0xf
  v_fmac_f32_dpp v243, v236, v19 row_newbcast:11 row_mask:0xf bank_mask:0xf
  v_fmac_f32_dpp v244, v236, v20 row_newbcast:11 row_mask:0xf bank_mask:0xf
  v_fmac_f32_dpp v245, v236, v21 row_newbcast:11 row_mask:0xf bank_mask:0xf
  v_fmac_f32_dpp v246, v236, v22 row_newbcast:11 row_mask:0xf bank_mask:0xf
  v_fmac_f32_dpp v247, v236, v23 row_newbcast:11 row_mask:0xf bank_mask:0xf
  s_waitcnt vmcnt(4)
  buffer_load_dwordx4 v[28:31], v2, s[44:47], s8 offen nt
  s_addk_i32 s8, 4096
  v_lshlrev_b32 v16, 16, v72
  v_and_b32 v17, s92, v72
  v_lshlrev_b32 v18, 16, v73
  v_and_b32 v19, s92, v73
  v_lshlrev_b32 v20, 16, v74
  v_and_b32 v21, s92, v74
  v_lshlrev_b32 v22, 16, v75
  v_and_b32 v23, s92, v75
  v_fmac_f32_dpp v240, v236, v16 row_newbcast:12 row_mask:0xf bank_mask:0xf
  v_fmac_f32_dpp v241, v236, v17 row_newbcast:12 row_mask:0xf bank_mask:0xf
  v_fmac_f32_dpp v242, v236, v18 row_newbcast:12 row_mask:0xf bank_mask:0xf
  v_fmac_f32_dpp v243, v236, v19 row_newbcast:12 row_mask:0xf bank_mask:0xf
  v_fmac_f32_dpp v244, v236, v20 row_newbcast:12 row_mask:0xf bank_mask:0xf
  v_fmac_f32_dpp v245, v236, v21 row_newbcast:12 row_mask:0xf bank_mask:0xf
  v_fmac_f32_dpp v246, v236, v22 row_newbcast:12 row_mask:0xf bank_mask:0xf
  v_fmac_f32_dpp v247, v236, v23 row_newbcast:12 row_mask:0xf bank_mask:0xf
  s_waitcnt vmcnt(4)
  buffer_load_dwordx4 v[32:35], v2, s[44:47], s8 offen nt
  s_addk_i32 s8, 4096
  v_lshlrev_b32 v16, 16, v76
  v_and_b32 v17, s92, v76
  v_lshlrev_b32 v18, 16, v77
  v_and_b32 v19, s92, v77
  v_lshlrev_b32 v20, 16, v78
  v_and_b32 v21, s92, v78
  v_lshlrev_b32 v22, 16, v79
  v_and_b32 v23, s92, v79
  v_fmac_f32_dpp v240, v236, v16 row_newbcast:13 row_mask:0xf bank_mask:0xf
  v_fmac_f32_dpp v241, v236, v17 row_newbcast:13 row_mask:0xf bank_mask:0xf
  v_fmac_f32_dpp v242, v236, v18 row_newbcast:13 row_mask:0xf bank_mask:0xf
  v_fmac_f32_dpp v243, v236, v19 row_newbcast:13 row_mask:0xf bank_mask:0xf
  v_fmac_f32_dpp v244, v236, v20 row_newbcast:13 row_mask:0xf bank_mask:0xf
  v_fmac_f32_dpp v245, v236, v21 row_newbcast:13 row_mask:0xf bank_mask:0xf
  v_fmac_f32_dpp v246, v236, v22 row_newbcast:13 row_mask:0xf bank_mask:0xf
  v_fmac_f32_dpp v247, v236, v23 row_newbcast:13 row_mask:0xf bank_mask:0xf
  s_waitcnt vmcnt(4)
  buffer_load_dwordx4 v[36:39], v2, s[44:47], s8 offen nt
  s_addk_i32 s8, 4096
  v_lshlrev_b32 v16, 16, v80
  v_and_b32 v17, s92, v80
  v_lshlrev_b32 v18, 16, v81
  v_and_b32 v19, s92, v81
  v_lshlrev_b32 v20, 16, v82
  v_and_b32 v21, s92, v82
  v_lshlrev_b32 v22, 16, v83
  v_and_b32 v23, s92, v83
  v_fmac_f32_dpp v240, v236, v16 row_newbcast:14 row_mask:0xf bank_mask:0xf
  v_fmac_f32_dpp v241, v236, v17 row_newbcast:14 row_mask:0xf bank_mask:0xf
  v_fmac_f32_dpp v242, v236, v18 row_newbcast:14 row_mask:0xf bank_mask:0xf
  v_fmac_f32_dpp v243, v236, v19 row_newbcast:14 row_mask:0xf bank_mask:0xf
  v_fmac_f32_dpp v244, v236, v20 row_newbcast:14 row_mask:0xf bank_mask:0xf
  v_fmac_f32_dpp v245, v236, v21 row_newbcast:14 row_mask:0xf bank_mask:0xf
  v_fmac_f32_dpp v246, v236, v22 row_newbcast:14 row_mask:0xf bank_mask:0xf
  v_fmac_f32_dpp v247, v236, v23 row_newbcast:14 row_mask:0xf bank_mask:0xf
  s_waitcnt vmcnt(4)
  buffer_load_dwordx4 v[40:43], v2, s[44:47], s8 offen nt
  s_addk_i32 s8, 4096
  v_lshlrev_b32 v16, 16, v84
  v_and_b32 v17, s92, v84
  v_lshlrev_b32 v18, 16, v85
  v_and_b32 v19, s92, v85
  v_lshlrev_b32 v20, 16, v86
  v_and_b32 v21, s92, v86
  v_lshlrev_b32 v22, 16, v87
  v_and_b32 v23, s92, v87
  v_fmac_f32_dpp v240, v236, v16 row_newbcast:15 row_mask:0xf bank_mask:0xf
  v_fmac_f32_dpp v241, v236, v17 row_newbcast:15 row_mask:0xf bank_mask:0xf
  v_fmac_f32_dpp v242, v236, v18 row_newbcast:15 row_mask:0xf bank_mask:0xf
  v_fmac_f32_dpp v243, v236, v19 row_newbcast:15 row_mask:0xf bank_mask:0xf
  v_fmac_f32_dpp v244, v236, v20 row_newbcast:15 row_mask:0xf bank_mask:0xf
  v_fmac_f32_dpp v245, v236, v21 row_newbcast:15 row_mask:0xf bank_mask:0xf
  v_fmac_f32_dpp v246, v236, v22 row_newbcast:15 row_mask:0xf bank_mask:0xf
  v_fmac_f32_dpp v247, v236, v23 row_newbcast:15 row_mask:0xf bank_mask:0xf
  v_mov_b32 v236, v237
  s_add_u32 s12, s12, 1
  s_cmp_lt_u32 s12, 16
  s_cbranch_scc1 L_vloopA
  v_permlane32_swap_b32 v240, v244
  v_permlane32_swap_b32 v241, v245
  v_permlane32_swap_b32 v242, v246
  v_permlane32_swap_b32 v243, v247
  v_add_f32 v240, v240, v244
  v_add_f32 v241, v241, v245
  v_add_f32 v242, v242, v246
  v_add_f32 v243, v243, v247
  s_nop 0
  v_permlane16_swap_b32 v240, v242
  v_permlane16_swap_b32 v241, v243
  v_add_f32 v240, v240, v242
  v_add_f32 v241, v241, v243
  ds_write_b64 v239, v[240:241] offset:2048
  v_add_f32_dpp v249, v249, v249 row_ror:8 row_mask:0xf bank_mask:0xf
  s_nop 1
  v_add_f32_dpp v249, v249, v249 row_ror:4 row_mask:0xf bank_mask:0xf
  s_nop 1
  v_add_f32_dpp v249, v249, v249 row_ror:2 row_mask:0xf bank_mask:0xf
  s_nop 1
  v_add_f32_dpp v249, v249, v249 row_ror:1 row_mask:0xf bank_mask:0xf
  v_mov_b32 v17, v249
  s_nop 1
  v_permlane16_swap_b32 v249, v17
  v_add_f32 v249, v249, v17
  v_mov_b32 v17, v249
  s_nop 1
  v_permlane32_swap_b32 v249, v17
  v_add_f32 v249, v249, v17
  v_mov_b32 v18, v248
  v_mov_b32 v19, v249
  s_lshl_b32 s7, s3, 3
  v_mov_b32 v1, s7
  ds_write_b64 v1, v[18:19] offset:20736
  s_waitcnt lgkmcnt(0)
  s_barrier
  s_barrier
  s_branch L_final
L_helper:
  s_sub_u32 s12, s3, 4
  s_mul_i32 s7, s5, 1152
  s_mul_i32 s14, s5, 9
  s_lshr_b32 s14, s14, 1
  s_add_u32 s15, s14, 0
  v_add_u32 v6, s15, v4
  v_subrev_u32 v5, 36, v6
  v_min_u32 v6, v6, v5
  v_lshlrev_b32 v6, 3, v6
  v_lshl_add_u32 v6, v3, 1, v6
  s_add_u32 s15, s14, 16
  v_add_u32 v7, s15, v4
  v_subrev_u32 v5, 36, v7
  v_min_u32 v7, v7, v5
  v_lshlrev_b32 v7, 3, v7
  v_lshl_add_u32 v7, v3, 1, v7
  s_add_u32 s15, s14, 32
  v_add_u32 v8, s15, v4
  v_subrev_u32 v5, 36, v8
  v_min_u32 v8, v8, v5
  v_lshlrev_b32 v8, 3, v8
  v_lshl_add_u32 v8, v3, 1, v8
  v_lshlrev_b32 v1, 4, v4
  v_lshl_add_u32 v1, v3, 13, v1
  s_mul_i32 s10, s12, 1179648
  s_lshl_b32 s11, s4, 8
  s_add_u32 s10, s10, s11
  s_add_u32 s15, s10, 1179648
  s_mov_b32 s9, s10
  s_lshl_b32 s14, s14, 15
  s_add_u32 s10, s10, s14
  s_mul_i32 s11, s12, 288
  s_mov_b32 s50, 4718592
  s_mov_b32 s51, 0x20000
  s_mov_b32 s54, 1152
  s_mov_b32 s55, 0x20000
  s_waitcnt lgkmcnt(0)
  s_add_u32 s52, s16, s7
  s_addc_u32 s53, s17, 0
  s_lshl_b32 s7, s5, 7
  s_add_u32 s7, s7, 3145728
  s_load_dword s26, s[42:43], s7
  s_mov_b32 s48, s22
  s_mov_b32 s49, s23
  buffer_load_ushort v6, v6, s[52:55], s11 offen
  buffer_load_ushort v7, v7, s[52:55], s11 offen
  buffer_load_ushort v8, v8, s[52:55], s11 offen
  buffer_load_dwordx4 v[24:27], v1, s[48:51], s10 offen
  s_add_u32 s10, s10, 32768
  s_cmp_eq_u32 s10, s15
  s_cselect_b32 s10, s9, s10
  buffer_load_dwordx4 v[28:31], v1, s[48:51], s10 offen
  s_add_u32 s10, s10, 32768
  s_cmp_eq_u32 s10, s15
  s_cselect_b32 s10, s9, s10
  buffer_load_dwordx4 v[32:35], v1, s[48:51], s10 offen
  s_add_u32 s10, s10, 32768
  s_cmp_eq_u32 s10, s15
  s_cselect_b32 s10, s9, s10
  buffer_load_dwordx4 v[36:39], v1, s[48:51], s10 offen
  s_add_u32 s10, s10, 32768
  s_cmp_eq_u32 s10, s15
  s_cselect_b32 s10, s9, s10
  buffer_load_dwordx4 v[40:43], v1, s[48:51], s10 offen
  s_add_u32 s10, s10, 32768
  s_cmp_eq_u32 s10, s15
  s_cselect_b32 s10, s9, s10
  buffer_load_dwordx4 v[44:47], v1, s[48:51], s10 offen
  s_add_u32 s10, s10, 32768
  s_cmp_eq_u32 s10, s15
  s_cselect_b32 s10, s9, s10
  buffer_load_dwordx4 v[48:51], v1, s[48:51], s10 offen
  s_add_u32 s10, s10, 32768
  s_cmp_eq_u32 s10, s15
  s_cselect_b32 s10, s9, s10
  buffer_load_dwordx4 v[52:55], v1, s[48:51], s10 offen
  s_add_u32 s10, s10, 32768
  s_cmp_eq_u32 s10, s15
  s_cselect_b32 s10, s9, s10
  buffer_load_dwordx4 v[56:59], v1, s[48:51], s10 offen
  s_add_u32 s10, s10, 32768
  s_cmp_eq_u32 s10, s15
  s_cselect_b32 s10, s9, s10
  buffer_load_dwordx4 v[60:63], v1, s[48:51], s10 offen
  s_add_u32 s10, s10, 32768
  s_cmp_eq_u32 s10, s15
  s_cselect_b32 s10, s9, s10
  buffer_load_dwordx4 v[64:67], v1, s[48:51], s10 offen
  s_add_u32 s10, s10, 32768
  s_cmp_eq_u32 s10, s15
  s_cselect_b32 s10, s9, s10
  buffer_load_dwordx4 v[68:71], v1, s[48:51], s10 offen
  s_add_u32 s10, s10, 32768
  s_cmp_eq_u32 s10, s15
  s_cselect_b32 s10, s9, s10
  buffer_load_dwordx4 v[72:75], v1, s[48:51], s10 offen
  s_add_u32 s10, s10, 32768
  s_cmp_eq_u32 s10, s15
  s_cselect_b32 s10, s9, s10
  buffer_load_dwordx4 v[76:79], v1, s[48:51], s10 offen
  s_add_u32 s10, s10, 32768
  s_cmp_eq_u32 s10, s15
  s_cselect_b32 s10, s9, s10
  buffer_load_dwordx4 v[80:83], v1, s[48:51], s10 offen
  s_add_u32 s10, s10, 32768
  s_cmp_eq_u32 s10, s15
  s_cselect_b32 s10, s9, s10
  buffer_load_dwordx4 v[84:87], v1, s[48:51], s10 offen
  s_add_u32 s10, s10, 32768
  s_cmp_eq_u32 s10, s15
  s_cselect_b32 s10, s9, s10
  s_mov_b32 s76, s24
  s_mov_b32 s77, s25
  s_mov_b32 s78, 4718592
  s_mov_b32 s79, 0x20000
  s_mov_b32 s84, s42
  s_mov_b32 s85, s43
  s_mov_b32 s86, 0x40000000
  s_mov_b32 s87, 0x20000
  s_mov_b32 s60, s36
  s_mov_b32 s61, s37
  s_mov_b32 s62, 1152
  s_mov_b32 s63, 0x20000
  s_mov_b32 s68, s30
  s_mov_b32 s69, s31
  s_mov_b32 s70, 9216
  s_mov_b32 s71, 0x20000
  v_mov_b32 v216, 0
  v_mov_b32 v217, 0
  v_mov_b32 v218, 0
  v_mov_b32 v219, 0
  v_mov_b32 v220, 0
  v_mov_b32 v221, 0
  v_mov_b32 v222, 0
  v_mov_b32 v223, 0
  v_mov_b32 v224, 0
  v_mov_b32 v225, 0
  v_mov_b32 v226, 0
  v_mov_b32 v227, 0
  v_mov_b32 v228, 0
  v_mov_b32 v229, 0
  v_mov_b32 v230, 0
  v_mov_b32 v231, 0
  s_waitcnt vmcnt(16)
  v_lshlrev_b32 v6, 16, v6
  v_lshlrev_b32 v7, 16, v7
  v_lshlrev_b32 v8, 16, v8
  s_waitcnt vmcnt(15)
  buffer_load_dwordx4 v[88:91], v1, s[48:51], s10 offen
  s_add_u32 s10, s10, 32768
  s_cmp_eq_u32 s10, s15
  s_cselect_b32 s10, s9, s10
  v_lshlrev_b32 v16, 16, v24
  v_and_b32 v17, s92, v24
  v_lshlrev_b32 v18, 16, v25
  v_and_b32 v19, s92, v25
  v_lshlrev_b32 v20, 16, v26
  v_and_b32 v21, s92, v26
  v_lshlrev_b32 v22, 16, v27
  v_and_b32 v23, s92, v27
  v_mul_f32_dpp v200, v6, v16 row_newbcast:0 row_mask:0xf bank_mask:0xf
  v_mul_f32_dpp v201, v6, v17 row_newbcast:0 row_mask:0xf bank_mask:0xf
  v_mul_f32_dpp v202, v6, v18 row_newbcast:0 row_mask:0xf bank_mask:0xf
  v_mul_f32_dpp v203, v6, v19 row_newbcast:0 row_mask:0xf bank_mask:0xf
  v_mul_f32_dpp v204, v6, v20 row_newbcast:0 row_mask:0xf bank_mask:0xf
  v_mul_f32_dpp v205, v6, v21 row_newbcast:0 row_mask:0xf bank_mask:0xf
  v_mul_f32_dpp v206, v6, v22 row_newbcast:0 row_mask:0xf bank_mask:0xf
  v_mul_f32_dpp v207, v6, v23 row_newbcast:0 row_mask:0xf bank_mask:0xf
  s_waitcnt vmcnt(15)
  buffer_load_dwordx4 v[92:95], v1, s[48:51], s10 offen
  s_add_u32 s10, s10, 32768
  s_cmp_eq_u32 s10, s15
  s_cselect_b32 s10, s9, s10
  v_lshlrev_b32 v16, 16, v28
  v_and_b32 v17, s92, v28
  v_lshlrev_b32 v18, 16, v29
  v_and_b32 v19, s92, v29
  v_lshlrev_b32 v20, 16, v30
  v_and_b32 v21, s92, v30
  v_lshlrev_b32 v22, 16, v31
  v_and_b32 v23, s92, v31
  v_fmac_f32_dpp v200, v6, v16 row_newbcast:1 row_mask:0xf bank_mask:0xf
  v_fmac_f32_dpp v201, v6, v17 row_newbcast:1 row_mask:0xf bank_mask:0xf
  v_fmac_f32_dpp v202, v6, v18 row_newbcast:1 row_mask:0xf bank_mask:0xf
  v_fmac_f32_dpp v203, v6, v19 row_newbcast:1 row_mask:0xf bank_mask:0xf
  v_fmac_f32_dpp v204, v6, v20 row_newbcast:1 row_mask:0xf bank_mask:0xf
  v_fmac_f32_dpp v205, v6, v21 row_newbcast:1 row_mask:0xf bank_mask:0xf
  v_fmac_f32_dpp v206, v6, v22 row_newbcast:1 row_mask:0xf bank_mask:0xf
  v_fmac_f32_dpp v207, v6, v23 row_newbcast:1 row_mask:0xf bank_mask:0xf
  s_waitcnt vmcnt(15)
  buffer_load_dwordx4 v[96:99], v1, s[48:51], s10 offen
  s_add_u32 s10, s10, 32768
  s_cmp_eq_u32 s10, s15
  s_cselect_b32 s10, s9, s10
  v_lshlrev_b32 v16, 16, v32
  v_and_b32 v17, s92, v32
  v_lshlrev_b32 v18, 16, v33
  v_and_b32 v19, s92, v33
  v_lshlrev_b32 v20, 16, v34
  v_and_b32 v21, s92, v34
  v_lshlrev_b32 v22, 16, v35
  v_and_b32 v23, s92, v35
  v_fmac_f32_dpp v200, v6, v16 row_newbcast:2 row_mask:0xf bank_mask:0xf
  v_fmac_f32_dpp v201, v6, v17 row_newbcast:2 row_mask:0xf bank_mask:0xf
  v_fmac_f32_dpp v202, v6, v18 row_newbcast:2 row_mask:0xf bank_mask:0xf
  v_fmac_f32_dpp v203, v6, v19 row_newbcast:2 row_mask:0xf bank_mask:0xf
  v_fmac_f32_dpp v204, v6, v20 row_newbcast:2 row_mask:0xf bank_mask:0xf
  v_fmac_f32_dpp v205, v6, v21 row_newbcast:2 row_mask:0xf bank_mask:0xf
  v_fmac_f32_dpp v206, v6, v22 row_newbcast:2 row_mask:0xf bank_mask:0xf
  v_fmac_f32_dpp v207, v6, v23 row_newbcast:2 row_mask:0xf bank_mask:0xf
  s_waitcnt vmcnt(15)
  buffer_load_dwordx4 v[100:103], v1, s[48:51], s10 offen
  s_add_u32 s10, s10, 32768
  s_cmp_eq_u32 s10, s15
  s_cselect_b32 s10, s9, s10
  v_lshlrev_b32 v16, 16, v36
  v_and_b32 v17, s92, v36
  v_lshlrev_b32 v18, 16, v37
  v_and_b32 v19, s92, v37
  v_lshlrev_b32 v20, 16, v38
  v_and_b32 v21, s92, v38
  v_lshlrev_b32 v22, 16, v39
  v_and_b32 v23, s92, v39
  v_fmac_f32_dpp v200, v6, v16 row_newbcast:3 row_mask:0xf bank_mask:0xf
  v_fmac_f32_dpp v201, v6, v17 row_newbcast:3 row_mask:0xf bank_mask:0xf
  v_fmac_f32_dpp v202, v6, v18 row_newbcast:3 row_mask:0xf bank_mask:0xf
  v_fmac_f32_dpp v203, v6, v19 row_newbcast:3 row_mask:0xf bank_mask:0xf
  v_fmac_f32_dpp v204, v6, v20 row_newbcast:3 row_mask:0xf bank_mask:0xf
  v_fmac_f32_dpp v205, v6, v21 row_newbcast:3 row_mask:0xf bank_mask:0xf
  v_fmac_f32_dpp v206, v6, v22 row_newbcast:3 row_mask:0xf bank_mask:0xf
  v_fmac_f32_dpp v207, v6, v23 row_newbcast:3 row_mask:0xf bank_mask:0xf
  s_waitcnt vmcnt(15)
  buffer_load_dwordx4 v[104:107], v1, s[48:51], s10 offen
  s_add_u32 s10, s10, 32768
  s_cmp_eq_u32 s10, s15
  s_cselect_b32 s10, s9, s10
  v_lshlrev_b32 v16, 16, v40
  v_and_b32 v17, s92, v40
  v_lshlrev_b32 v18, 16, v41
  v_and_b32 v19, s92, v41
  v_lshlrev_b32 v20, 16, v42
  v_and_b32 v21, s92, v42
  v_lshlrev_b32 v22, 16, v43
  v_and_b32 v23, s92, v43
  v_fmac_f32_dpp v200, v6, v16 row_newbcast:4 row_mask:0xf bank_mask:0xf
  v_fmac_f32_dpp v201, v6, v17 row_newbcast:4 row_mask:0xf bank_mask:0xf
  v_fmac_f32_dpp v202, v6, v18 row_newbcast:4 row_mask:0xf bank_mask:0xf
  v_fmac_f32_dpp v203, v6, v19 row_newbcast:4 row_mask:0xf bank_mask:0xf
  v_fmac_f32_dpp v204, v6, v20 row_newbcast:4 row_mask:0xf bank_mask:0xf
  v_fmac_f32_dpp v205, v6, v21 row_newbcast:4 row_mask:0xf bank_mask:0xf
  v_fmac_f32_dpp v206, v6, v22 row_newbcast:4 row_mask:0xf bank_mask:0xf
  v_fmac_f32_dpp v207, v6, v23 row_newbcast:4 row_mask:0xf bank_mask:0xf
  s_waitcnt vmcnt(15)
  buffer_load_dwordx4 v[108:111], v1, s[48:51], s10 offen
  s_add_u32 s10, s10, 32768
  s_cmp_eq_u32 s10, s15
  s_cselect_b32 s10, s9, s10
  v_lshlrev_b32 v16, 16, v44
  v_and_b32 v17, s92, v44
  v_lshlrev_b32 v18, 16, v45
  v_and_b32 v19, s92, v45
  v_lshlrev_b32 v20, 16, v46
  v_and_b32 v21, s92, v46
  v_lshlrev_b32 v22, 16, v47
  v_and_b32 v23, s92, v47
  v_fmac_f32_dpp v200, v6, v16 row_newbcast:5 row_mask:0xf bank_mask:0xf
  v_fmac_f32_dpp v201, v6, v17 row_newbcast:5 row_mask:0xf bank_mask:0xf
  v_fmac_f32_dpp v202, v6, v18 row_newbcast:5 row_mask:0xf bank_mask:0xf
  v_fmac_f32_dpp v203, v6, v19 row_newbcast:5 row_mask:0xf bank_mask:0xf
  v_fmac_f32_dpp v204, v6, v20 row_newbcast:5 row_mask:0xf bank_mask:0xf
  v_fmac_f32_dpp v205, v6, v21 row_newbcast:5 row_mask:0xf bank_mask:0xf
  v_fmac_f32_dpp v206, v6, v22 row_newbcast:5 row_mask:0xf bank_mask:0xf
  v_fmac_f32_dpp v207, v6, v23 row_newbcast:5 row_mask:0xf bank_mask:0xf
  s_waitcnt vmcnt(15)
  buffer_load_dwordx4 v[112:115], v1, s[48:51], s10 offen
  s_add_u32 s10, s10, 32768
  s_cmp_eq_u32 s10, s15
  s_cselect_b32 s10, s9, s10
  v_lshlrev_b32 v16, 16, v48
  v_and_b32 v17, s92, v48
  v_lshlrev_b32 v18, 16, v49
  v_and_b32 v19, s92, v49
  v_lshlrev_b32 v20, 16, v50
  v_and_b32 v21, s92, v50
  v_lshlrev_b32 v22, 16, v51
  v_and_b32 v23, s92, v51
  v_fmac_f32_dpp v200, v6, v16 row_newbcast:6 row_mask:0xf bank_mask:0xf
  v_fmac_f32_dpp v201, v6, v17 row_newbcast:6 row_mask:0xf bank_mask:0xf
  v_fmac_f32_dpp v202, v6, v18 row_newbcast:6 row_mask:0xf bank_mask:0xf
  v_fmac_f32_dpp v203, v6, v19 row_newbcast:6 row_mask:0xf bank_mask:0xf
  v_fmac_f32_dpp v204, v6, v20 row_newbcast:6 row_mask:0xf bank_mask:0xf
  v_fmac_f32_dpp v205, v6, v21 row_newbcast:6 row_mask:0xf bank_mask:0xf
  v_fmac_f32_dpp v206, v6, v22 row_newbcast:6 row_mask:0xf bank_mask:0xf
  v_fmac_f32_dpp v207, v6, v23 row_newbcast:6 row_mask:0xf bank_mask:0xf
  s_waitcnt vmcnt(15)
  buffer_load_dwordx4 v[116:119], v1, s[48:51], s10 offen
  s_add_u32 s10, s10, 32768
  s_cmp_eq_u32 s10, s15
  s_cselect_b32 s10, s9, s10
  v_lshlrev_b32 v16, 16, v52
  v_and_b32 v17, s92, v52
  v_lshlrev_b32 v18, 16, v53
  v_and_b32 v19, s92, v53
  v_lshlrev_b32 v20, 16, v54
  v_and_b32 v21, s92, v54
  v_lshlrev_b32 v22, 16, v55
  v_and_b32 v23, s92, v55
  v_fmac_f32_dpp v200, v6, v16 row_newbcast:7 row_mask:0xf bank_mask:0xf
  v_fmac_f32_dpp v201, v6, v17 row_newbcast:7 row_mask:0xf bank_mask:0xf
  v_fmac_f32_dpp v202, v6, v18 row_newbcast:7 row_mask:0xf bank_mask:0xf
  v_fmac_f32_dpp v203, v6, v19 row_newbcast:7 row_mask:0xf bank_mask:0xf
  v_fmac_f32_dpp v204, v6, v20 row_newbcast:7 row_mask:0xf bank_mask:0xf
  v_fmac_f32_dpp v205, v6, v21 row_newbcast:7 row_mask:0xf bank_mask:0xf
  v_fmac_f32_dpp v206, v6, v22 row_newbcast:7 row_mask:0xf bank_mask:0xf
  v_fmac_f32_dpp v207, v6, v23 row_newbcast:7 row_mask:0xf bank_mask:0xf
  s_waitcnt vmcnt(15)
  buffer_load_dwordx4 v[120:123], v1, s[48:51], s10 offen
  s_add_u32 s10, s10, 32768
  s_cmp_eq_u32 s10, s15
  s_cselect_b32 s10, s9, s10
  v_lshlrev_b32 v16, 16, v56
  v_and_b32 v17, s92, v56
  v_lshlrev_b32 v18, 16, v57
  v_and_b32 v19, s92, v57
  v_lshlrev_b32 v20, 16, v58
  v_and_b32 v21, s92, v58
  v_lshlrev_b32 v22, 16, v59
  v_and_b32 v23, s92, v59
  v_fmac_f32_dpp v200, v6, v16 row_newbcast:8 row_mask:0xf bank_mask:0xf
  v_fmac_f32_dpp v201, v6, v17 row_newbcast:8 row_mask:0xf bank_mask:0xf
  v_fmac_f32_dpp v202, v6, v18 row_newbcast:8 row_mask:0xf bank_mask:0xf
  v_fmac_f32_dpp v203, v6, v19 row_newbcast:8 row_mask:0xf bank_mask:0xf
  v_fmac_f32_dpp v204, v6, v20 row_newbcast:8 row_mask:0xf bank_mask:0xf
  v_fmac_f32_dpp v205, v6, v21 row_newbcast:8 row_mask:0xf bank_mask:0xf
  v_fmac_f32_dpp v206, v6, v22 row_newbcast:8 row_mask:0xf bank_mask:0xf
  v_fmac_f32_dpp v207, v6, v23 row_newbcast:8 row_mask:0xf bank_mask:0xf
  s_waitcnt vmcnt(15)
  buffer_load_dwordx4 v[124:127], v1, s[48:51], s10 offen
  s_add_u32 s10, s10, 32768
  s_cmp_eq_u32 s10, s15
  s_cselect_b32 s10, s9, s10
  v_lshlrev_b32 v16, 16, v60
  v_and_b32 v17, s92, v60
  v_lshlrev_b32 v18, 16, v61
  v_and_b32 v19, s92, v61
  v_lshlrev_b32 v20, 16, v62
  v_and_b32 v21, s92, v62
  v_lshlrev_b32 v22, 16, v63
  v_and_b32 v23, s92, v63
  v_fmac_f32_dpp v200, v6, v16 row_newbcast:9 row_mask:0xf bank_mask:0xf
  v_fmac_f32_dpp v201, v6, v17 row_newbcast:9 row_mask:0xf bank_mask:0xf
  v_fmac_f32_dpp v202, v6, v18 row_newbcast:9 row_mask:0xf bank_mask:0xf
  v_fmac_f32_dpp v203, v6, v19 row_newbcast:9 row_mask:0xf bank_mask:0xf
  v_fmac_f32_dpp v204, v6, v20 row_newbcast:9 row_mask:0xf bank_mask:0xf
  v_fmac_f32_dpp v205, v6, v21 row_newbcast:9 row_mask:0xf bank_mask:0xf
  v_fmac_f32_dpp v206, v6, v22 row_newbcast:9 row_mask:0xf bank_mask:0xf
  v_fmac_f32_dpp v207, v6, v23 row_newbcast:9 row_mask:0xf bank_mask:0xf
  s_waitcnt vmcnt(15)
  buffer_load_dwordx4 v[128:131], v1, s[48:51], s10 offen
  s_add_u32 s10, s10, 32768
  s_cmp_eq_u32 s10, s15
  s_cselect_b32 s10, s9, s10
  v_lshlrev_b32 v16, 16, v64
  v_and_b32 v17, s92, v64
  v_lshlrev_b32 v18, 16, v65
  v_and_b32 v19, s92, v65
  v_lshlrev_b32 v20, 16, v66
  v_and_b32 v21, s92, v66
  v_lshlrev_b32 v22, 16, v67
  v_and_b32 v23, s92, v67
  v_fmac_f32_dpp v200, v6, v16 row_newbcast:10 row_mask:0xf bank_mask:0xf
  v_fmac_f32_dpp v201, v6, v17 row_newbcast:10 row_mask:0xf bank_mask:0xf
  v_fmac_f32_dpp v202, v6, v18 row_newbcast:10 row_mask:0xf bank_mask:0xf
  v_fmac_f32_dpp v203, v6, v19 row_newbcast:10 row_mask:0xf bank_mask:0xf
  v_fmac_f32_dpp v204, v6, v20 row_newbcast:10 row_mask:0xf bank_mask:0xf
  v_fmac_f32_dpp v205, v6, v21 row_newbcast:10 row_mask:0xf bank_mask:0xf
  v_fmac_f32_dpp v206, v6, v22 row_newbcast:10 row_mask:0xf bank_mask:0xf
  v_fmac_f32_dpp v207, v6, v23 row_newbcast:10 row_mask:0xf bank_mask:0xf
  s_waitcnt vmcnt(15)
  buffer_load_dwordx4 v[132:135], v1, s[48:51], s10 offen
  s_add_u32 s10, s10, 32768
  s_cmp_eq_u32 s10, s15
  s_cselect_b32 s10, s9, s10
  v_lshlrev_b32 v16, 16, v68
  v_and_b32 v17, s92, v68
  v_lshlrev_b32 v18, 16, v69
  v_and_b32 v19, s92, v69
  v_lshlrev_b32 v20, 16, v70
  v_and_b32 v21, s92, v70
  v_lshlrev_b32 v22, 16, v71
  v_and_b32 v23, s92, v71
  v_fmac_f32_dpp v200, v6, v16 row_newbcast:11 row_mask:0xf bank_mask:0xf
  v_fmac_f32_dpp v201, v6, v17 row_newbcast:11 row_mask:0xf bank_mask:0xf
  v_fmac_f32_dpp v202, v6, v18 row_newbcast:11 row_mask:0xf bank_mask:0xf
  v_fmac_f32_dpp v203, v6, v19 row_newbcast:11 row_mask:0xf bank_mask:0xf
  v_fmac_f32_dpp v204, v6, v20 row_newbcast:11 row_mask:0xf bank_mask:0xf
  v_fmac_f32_dpp v205, v6, v21 row_newbcast:11 row_mask:0xf bank_mask:0xf
  v_fmac_f32_dpp v206, v6, v22 row_newbcast:11 row_mask:0xf bank_mask:0xf
  v_fmac_f32_dpp v207, v6, v23 row_newbcast:11 row_mask:0xf bank_mask:0xf
  s_waitcnt vmcnt(15)
  buffer_load_dwordx4 v[136:139], v1, s[48:51], s10 offen
  s_add_u32 s10, s10, 32768
  s_cmp_eq_u32 s10, s15
  s_cselect_b32 s10, s9, s10
  v_lshlrev_b32 v16, 16, v72
  v_and_b32 v17, s92, v72
  v_lshlrev_b32 v18, 16, v73
  v_and_b32 v19, s92, v73
  v_lshlrev_b32 v20, 16, v74
  v_and_b32 v21, s92, v74
  v_lshlrev_b32 v22, 16, v75
  v_and_b32 v23, s92, v75
  v_fmac_f32_dpp v200, v6, v16 row_newbcast:12 row_mask:0xf bank_mask:0xf
  v_fmac_f32_dpp v201, v6, v17 row_newbcast:12 row_mask:0xf bank_mask:0xf
  v_fmac_f32_dpp v202, v6, v18 row_newbcast:12 row_mask:0xf bank_mask:0xf
  v_fmac_f32_dpp v203, v6, v19 row_newbcast:12 row_mask:0xf bank_mask:0xf
  v_fmac_f32_dpp v204, v6, v20 row_newbcast:12 row_mask:0xf bank_mask:0xf
  v_fmac_f32_dpp v205, v6, v21 row_newbcast:12 row_mask:0xf bank_mask:0xf
  v_fmac_f32_dpp v206, v6, v22 row_newbcast:12 row_mask:0xf bank_mask:0xf
  v_fmac_f32_dpp v207, v6, v23 row_newbcast:12 row_mask:0xf bank_mask:0xf
  s_waitcnt vmcnt(15)
  buffer_load_dwordx4 v[140:143], v1, s[48:51], s10 offen
  s_add_u32 s10, s10, 32768
  s_cmp_eq_u32 s10, s15
  s_cselect_b32 s10, s9, s10
  v_lshlrev_b32 v16, 16, v76
  v_and_b32 v17, s92, v76
  v_lshlrev_b32 v18, 16, v77
  v_and_b32 v19, s92, v77
  v_lshlrev_b32 v20, 16, v78
  v_and_b32 v21, s92, v78
  v_lshlrev_b32 v22, 16, v79
  v_and_b32 v23, s92, v79
  v_fmac_f32_dpp v200, v6, v16 row_newbcast:13 row_mask:0xf bank_mask:0xf
  v_fmac_f32_dpp v201, v6, v17 row_newbcast:13 row_mask:0xf bank_mask:0xf
  v_fmac_f32_dpp v202, v6, v18 row_newbcast:13 row_mask:0xf bank_mask:0xf
  v_fmac_f32_dpp v203, v6, v19 row_newbcast:13 row_mask:0xf bank_mask:0xf
  v_fmac_f32_dpp v204, v6, v20 row_newbcast:13 row_mask:0xf bank_mask:0xf
  v_fmac_f32_dpp v205, v6, v21 row_newbcast:13 row_mask:0xf bank_mask:0xf
  v_fmac_f32_dpp v206, v6, v22 row_newbcast:13 row_mask:0xf bank_mask:0xf
  v_fmac_f32_dpp v207, v6, v23 row_newbcast:13 row_mask:0xf bank_mask:0xf
  s_waitcnt vmcnt(15)
  buffer_load_dwordx4 v[144:147], v1, s[48:51], s10 offen
  s_add_u32 s10, s10, 32768
  s_cmp_eq_u32 s10, s15
  s_cselect_b32 s10, s9, s10
  v_lshlrev_b32 v16, 16, v80
  v_and_b32 v17, s92, v80
  v_lshlrev_b32 v18, 16, v81
  v_and_b32 v19, s92, v81
  v_lshlrev_b32 v20, 16, v82
  v_and_b32 v21, s92, v82
  v_lshlrev_b32 v22, 16, v83
  v_and_b32 v23, s92, v83
  v_fmac_f32_dpp v200, v6, v16 row_newbcast:14 row_mask:0xf bank_mask:0xf
  v_fmac_f32_dpp v201, v6, v17 row_newbcast:14 row_mask:0xf bank_mask:0xf
  v_fmac_f32_dpp v202, v6, v18 row_newbcast:14 row_mask:0xf bank_mask:0xf
  v_fmac_f32_dpp v203, v6, v19 row_newbcast:14 row_mask:0xf bank_mask:0xf
  v_fmac_f32_dpp v204, v6, v20 row_newbcast:14 row_mask:0xf bank_mask:0xf
  v_fmac_f32_dpp v205, v6, v21 row_newbcast:14 row_mask:0xf bank_mask:0xf
  v_fmac_f32_dpp v206, v6, v22 row_newbcast:14 row_mask:0xf bank_mask:0xf
  v_fmac_f32_dpp v207, v6, v23 row_newbcast:14 row_mask:0xf bank_mask:0xf
  s_waitcnt vmcnt(15)
  buffer_load_dwordx4 v[148:151], v1, s[48:51], s10 offen
  s_add_u32 s10, s10, 32768
  s_cmp_eq_u32 s10, s15
  s_cselect_b32 s10, s9, s10
  v_lshlrev_b32 v16, 16, v84
  v_and_b32 v17, s92, v84
  v_lshlrev_b32 v18, 16, v85
  v_and_b32 v19, s92, v85
  v_lshlrev_b32 v20, 16, v86
  v_and_b32 v21, s92, v86
  v_lshlrev_b32 v22, 16, v87
  v_and_b32 v23, s92, v87
  v_fmac_f32_dpp v200, v6, v16 row_newbcast:15 row_mask:0xf bank_mask:0xf
  v_fmac_f32_dpp v201, v6, v17 row_newbcast:15 row_mask:0xf bank_mask:0xf
  v_fmac_f32_dpp v202, v6, v18 row_newbcast:15 row_mask:0xf bank_mask:0xf
  v_fmac_f32_dpp v203, v6, v19 row_newbcast:15 row_mask:0xf bank_mask:0xf
  v_fmac_f32_dpp v204, v6, v20 row_newbcast:15 row_mask:0xf bank_mask:0xf
  v_fmac_f32_dpp v205, v6, v21 row_newbcast:15 row_mask:0xf bank_mask:0xf
  v_fmac_f32_dpp v206, v6, v22 row_newbcast:15 row_mask:0xf bank_mask:0xf
  v_fmac_f32_dpp v207, v6, v23 row_newbcast:15 row_mask:0xf bank_mask:0xf
  s_waitcnt vmcnt(15)
  buffer_load_dwordx4 v[152:155], v1, s[48:51], s10 offen
  s_add_u32 s10, s10, 32768
  s_cmp_eq_u32 s10, s15
  s_cselect_b32 s10, s9, s10
  v_lshlrev_b32 v16, 16, v88
  v_and_b32 v17, s92, v88
  v_lshlrev_b32 v18, 16, v89
  v_and_b32 v19, s92, v89
  v_lshlrev_b32 v20, 16, v90
  v_and_b32 v21, s92, v90
  v_lshlrev_b32 v22, 16, v91
  v_and_b32 v23, s92, v91
  v_fmac_f32_dpp v200, v7, v16 row_newbcast:0 row_mask:0xf bank_mask:0xf
  v_fmac_f32_dpp v201, v7, v17 row_newbcast:0 row_mask:0xf bank_mask:0xf
  v_fmac_f32_dpp v202, v7, v18 row_newbcast:0 row_mask:0xf bank_mask:0xf
  v_fmac_f32_dpp v203, v7, v19 row_newbcast:0 row_mask:0xf bank_mask:0xf
  v_fmac_f32_dpp v204, v7, v20 row_newbcast:0 row_mask:0xf bank_mask:0xf
  v_fmac_f32_dpp v205, v7, v21 row_newbcast:0 row_mask:0xf bank_mask:0xf
  v_fmac_f32_dpp v206, v7, v22 row_newbcast:0 row_mask:0xf bank_mask:0xf
  v_fmac_f32_dpp v207, v7, v23 row_newbcast:0 row_mask:0xf bank_mask:0xf
  s_waitcnt vmcnt(15)
  buffer_load_dwordx4 v[156:159], v1, s[48:51], s10 offen
  s_add_u32 s10, s10, 32768
  s_cmp_eq_u32 s10, s15
  s_cselect_b32 s10, s9, s10
  v_lshlrev_b32 v16, 16, v92
  v_and_b32 v17, s92, v92
  v_lshlrev_b32 v18, 16, v93
  v_and_b32 v19, s92, v93
  v_lshlrev_b32 v20, 16, v94
  v_and_b32 v21, s92, v94
  v_lshlrev_b32 v22, 16, v95
  v_and_b32 v23, s92, v95
  v_fmac_f32_dpp v200, v7, v16 row_newbcast:1 row_mask:0xf bank_mask:0xf
  v_fmac_f32_dpp v201, v7, v17 row_newbcast:1 row_mask:0xf bank_mask:0xf
  v_fmac_f32_dpp v202, v7, v18 row_newbcast:1 row_mask:0xf bank_mask:0xf
  v_fmac_f32_dpp v203, v7, v19 row_newbcast:1 row_mask:0xf bank_mask:0xf
  v_fmac_f32_dpp v204, v7, v20 row_newbcast:1 row_mask:0xf bank_mask:0xf
  v_fmac_f32_dpp v205, v7, v21 row_newbcast:1 row_mask:0xf bank_mask:0xf
  v_fmac_f32_dpp v206, v7, v22 row_newbcast:1 row_mask:0xf bank_mask:0xf
  v_fmac_f32_dpp v207, v7, v23 row_newbcast:1 row_mask:0xf bank_mask:0xf
  s_waitcnt vmcnt(15)
  buffer_load_dwordx4 v[160:163], v1, s[48:51], s10 offen
  s_add_u32 s10, s10, 32768
  s_cmp_eq_u32 s10, s15
  s_cselect_b32 s10, s9, s10
  v_lshlrev_b32 v16, 16, v96
  v_and_b32 v17, s92, v96
  v_lshlrev_b32 v18, 16, v97
  v_and_b32 v19, s92, v97
  v_lshlrev_b32 v20, 16, v98
  v_and_b32 v21, s92, v98
  v_lshlrev_b32 v22, 16, v99
  v_and_b32 v23, s92, v99
  v_fmac_f32_dpp v200, v7, v16 row_newbcast:2 row_mask:0xf bank_mask:0xf
  v_fmac_f32_dpp v201, v7, v17 row_newbcast:2 row_mask:0xf bank_mask:0xf
  v_fmac_f32_dpp v202, v7, v18 row_newbcast:2 row_mask:0xf bank_mask:0xf
  v_fmac_f32_dpp v203, v7, v19 row_newbcast:2 row_mask:0xf bank_mask:0xf
  v_fmac_f32_dpp v204, v7, v20 row_newbcast:2 row_mask:0xf bank_mask:0xf
  v_fmac_f32_dpp v205, v7, v21 row_newbcast:2 row_mask:0xf bank_mask:0xf
  v_fmac_f32_dpp v206, v7, v22 row_newbcast:2 row_mask:0xf bank_mask:0xf
  v_fmac_f32_dpp v207, v7, v23 row_newbcast:2 row_mask:0xf bank_mask:0xf
  s_waitcnt vmcnt(15)
  buffer_load_dwordx4 v[164:167], v1, s[48:51], s10 offen
  v_lshlrev_b32 v16, 16, v100
  v_and_b32 v17, s92, v100
  v_lshlrev_b32 v18, 16, v101
  v_and_b32 v19, s92, v101
  v_lshlrev_b32 v20, 16, v102
  v_and_b32 v21, s92, v102
  v_lshlrev_b32 v22, 16, v103
  v_and_b32 v23, s92, v103
  v_fmac_f32_dpp v200, v7, v16 row_newbcast:3 row_mask:0xf bank_mask:0xf
  v_fmac_f32_dpp v201, v7, v17 row_newbcast:3 row_mask:0xf bank_mask:0xf
  v_fmac_f32_dpp v202, v7, v18 row_newbcast:3 row_mask:0xf bank_mask:0xf
  v_fmac_f32_dpp v203, v7, v19 row_newbcast:3 row_mask:0xf bank_mask:0xf
  v_fmac_f32_dpp v204, v7, v20 row_newbcast:3 row_mask:0xf bank_mask:0xf
  v_fmac_f32_dpp v205, v7, v21 row_newbcast:3 row_mask:0xf bank_mask:0xf
  v_fmac_f32_dpp v206, v7, v22 row_newbcast:3 row_mask:0xf bank_mask:0xf
  v_fmac_f32_dpp v207, v7, v23 row_newbcast:3 row_mask:0xf bank_mask:0xf
  s_waitcnt vmcnt(15)
  v_lshlrev_b32 v5, 2, v0
  buffer_load_dword v232, v5, s[52:55], 0 offen offset:0
  buffer_load_dword v233, v5, s[52:55], 0 offen offset:256
  buffer_load_dword v234, v5, s[52:55], 0 offen offset:512
  buffer_load_dword v235, v5, s[52:55], 0 offen offset:768
  buffer_load_dword v236, v5, s[52:55], 0 offen offset:1024
  buffer_load_dword v237, v5, s[60:63], 0 offen offset:0
  buffer_load_dword v238, v5, s[60:63], 0 offen offset:256
  buffer_load_dword v239, v5, s[60:63], 0 offen offset:512
  buffer_load_dword v240, v5, s[60:63], 0 offen offset:768
  buffer_load_dword v241, v5, s[60:63], 0 offen offset:1024
  s_mul_i32 s7, s4, 288
  s_mul_i32 s11, s12, 72
  s_add_u32 s7, s7, s11
  v_lshlrev_b32 v5, 1, v0
  buffer_load_ushort v242, v5, s[68:71], s7 offen
  v_lshlrev_b32 v16, 16, v104
  v_and_b32 v17, s92, v104
  v_lshlrev_b32 v18, 16, v105
  v_and_b32 v19, s92, v105
  v_lshlrev_b32 v20, 16, v106
  v_and_b32 v21, s92, v106
  v_lshlrev_b32 v22, 16, v107
  v_and_b32 v23, s92, v107
  v_fmac_f32_dpp v200, v7, v16 row_newbcast:4 row_mask:0xf bank_mask:0xf
  v_fmac_f32_dpp v201, v7, v17 row_newbcast:4 row_mask:0xf bank_mask:0xf
  v_fmac_f32_dpp v202, v7, v18 row_newbcast:4 row_mask:0xf bank_mask:0xf
  v_fmac_f32_dpp v203, v7, v19 row_newbcast:4 row_mask:0xf bank_mask:0xf
  v_fmac_f32_dpp v204, v7, v20 row_newbcast:4 row_mask:0xf bank_mask:0xf
  v_fmac_f32_dpp v205, v7, v21 row_newbcast:4 row_mask:0xf bank_mask:0xf
  v_fmac_f32_dpp v206, v7, v22 row_newbcast:4 row_mask:0xf bank_mask:0xf
  v_fmac_f32_dpp v207, v7, v23 row_newbcast:4 row_mask:0xf bank_mask:0xf
  s_waitcnt vmcnt(25)
  v_lshlrev_b32 v16, 16, v108
  v_and_b32 v17, s92, v108
  v_lshlrev_b32 v18, 16, v109
  v_and_b32 v19, s92, v109
  v_lshlrev_b32 v20, 16, v110
  v_and_b32 v21, s92, v110
  v_lshlrev_b32 v22, 16, v111
  v_and_b32 v23, s92, v111
  v_fmac_f32_dpp v200, v7, v16 row_newbcast:5 row_mask:0xf bank_mask:0xf
  v_fmac_f32_dpp v201, v7, v17 row_newbcast:5 row_mask:0xf bank_mask:0xf
  v_fmac_f32_dpp v202, v7, v18 row_newbcast:5 row_mask:0xf bank_mask:0xf
  v_fmac_f32_dpp v203, v7, v19 row_newbcast:5 row_mask:0xf bank_mask:0xf
  v_fmac_f32_dpp v204, v7, v20 row_newbcast:5 row_mask:0xf bank_mask:0xf
  v_fmac_f32_dpp v205, v7, v21 row_newbcast:5 row_mask:0xf bank_mask:0xf
  v_fmac_f32_dpp v206, v7, v22 row_newbcast:5 row_mask:0xf bank_mask:0xf
  v_fmac_f32_dpp v207, v7, v23 row_newbcast:5 row_mask:0xf bank_mask:0xf
  s_waitcnt vmcnt(24)
  v_lshlrev_b32 v16, 16, v112
  v_and_b32 v17, s92, v112
  v_lshlrev_b32 v18, 16, v113
  v_and_b32 v19, s92, v113
  v_lshlrev_b32 v20, 16, v114
  v_and_b32 v21, s92, v114
  v_lshlrev_b32 v22, 16, v115
  v_and_b32 v23, s92, v115
  v_fmac_f32_dpp v200, v7, v16 row_newbcast:6 row_mask:0xf bank_mask:0xf
  v_fmac_f32_dpp v201, v7, v17 row_newbcast:6 row_mask:0xf bank_mask:0xf
  v_fmac_f32_dpp v202, v7, v18 row_newbcast:6 row_mask:0xf bank_mask:0xf
  v_fmac_f32_dpp v203, v7, v19 row_newbcast:6 row_mask:0xf bank_mask:0xf
  v_fmac_f32_dpp v204, v7, v20 row_newbcast:6 row_mask:0xf bank_mask:0xf
  v_fmac_f32_dpp v205, v7, v21 row_newbcast:6 row_mask:0xf bank_mask:0xf
  v_fmac_f32_dpp v206, v7, v22 row_newbcast:6 row_mask:0xf bank_mask:0xf
  v_fmac_f32_dpp v207, v7, v23 row_newbcast:6 row_mask:0xf bank_mask:0xf
  s_waitcnt vmcnt(23)
  v_lshlrev_b32 v16, 16, v116
  v_and_b32 v17, s92, v116
  v_lshlrev_b32 v18, 16, v117
  v_and_b32 v19, s92, v117
  v_lshlrev_b32 v20, 16, v118
  v_and_b32 v21, s92, v118
  v_lshlrev_b32 v22, 16, v119
  v_and_b32 v23, s92, v119
  v_fmac_f32_dpp v200, v7, v16 row_newbcast:7 row_mask:0xf bank_mask:0xf
  v_fmac_f32_dpp v201, v7, v17 row_newbcast:7 row_mask:0xf bank_mask:0xf
  v_fmac_f32_dpp v202, v7, v18 row_newbcast:7 row_mask:0xf bank_mask:0xf
  v_fmac_f32_dpp v203, v7, v19 row_newbcast:7 row_mask:0xf bank_mask:0xf
  v_fmac_f32_dpp v204, v7, v20 row_newbcast:7 row_mask:0xf bank_mask:0xf
  v_fmac_f32_dpp v205, v7, v21 row_newbcast:7 row_mask:0xf bank_mask:0xf
  v_fmac_f32_dpp v206, v7, v22 row_newbcast:7 row_mask:0xf bank_mask:0xf
  v_fmac_f32_dpp v207, v7, v23 row_newbcast:7 row_mask:0xf bank_mask:0xf
  s_waitcnt vmcnt(22)
  v_lshlrev_b32 v16, 16, v120
  v_and_b32 v17, s92, v120
  v_lshlrev_b32 v18, 16, v121
  v_and_b32 v19, s92, v121
  v_lshlrev_b32 v20, 16, v122
  v_and_b32 v21, s92, v122
  v_lshlrev_b32 v22, 16, v123
  v_and_b32 v23, s92, v123
  v_fmac_f32_dpp v200, v7, v16 row_newbcast:8 row_mask:0xf bank_mask:0xf
  v_fmac_f32_dpp v201, v7, v17 row_newbcast:8 row_mask:0xf bank_mask:0xf
  v_fmac_f32_dpp v202, v7, v18 row_newbcast:8 row_mask:0xf bank_mask:0xf
  v_fmac_f32_dpp v203, v7, v19 row_newbcast:8 row_mask:0xf bank_mask:0xf
  v_fmac_f32_dpp v204, v7, v20 row_newbcast:8 row_mask:0xf bank_mask:0xf
  v_fmac_f32_dpp v205, v7, v21 row_newbcast:8 row_mask:0xf bank_mask:0xf
  v_fmac_f32_dpp v206, v7, v22 row_newbcast:8 row_mask:0xf bank_mask:0xf
  v_fmac_f32_dpp v207, v7, v23 row_newbcast:8 row_mask:0xf bank_mask:0xf
  s_waitcnt vmcnt(21)
  v_lshlrev_b32 v16, 16, v124
  v_and_b32 v17, s92, v124
  v_lshlrev_b32 v18, 16, v125
  v_and_b32 v19, s92, v125
  v_lshlrev_b32 v20, 16, v126
  v_and_b32 v21, s92, v126
  v_lshlrev_b32 v22, 16, v127
  v_and_b32 v23, s92, v127
  v_fmac_f32_dpp v200, v7, v16 row_newbcast:9 row_mask:0xf bank_mask:0xf
  v_fmac_f32_dpp v201, v7, v17 row_newbcast:9 row_mask:0xf bank_mask:0xf
  v_fmac_f32_dpp v202, v7, v18 row_newbcast:9 row_mask:0xf bank_mask:0xf
  v_fmac_f32_dpp v203, v7, v19 row_newbcast:9 row_mask:0xf bank_mask:0xf
  v_fmac_f32_dpp v204, v7, v20 row_newbcast:9 row_mask:0xf bank_mask:0xf
  v_fmac_f32_dpp v205, v7, v21 row_newbcast:9 row_mask:0xf bank_mask:0xf
  v_fmac_f32_dpp v206, v7, v22 row_newbcast:9 row_mask:0xf bank_mask:0xf
  v_fmac_f32_dpp v207, v7, v23 row_newbcast:9 row_mask:0xf bank_mask:0xf
  s_waitcnt vmcnt(20)
  v_lshlrev_b32 v16, 16, v128
  v_and_b32 v17, s92, v128
  v_lshlrev_b32 v18, 16, v129
  v_and_b32 v19, s92, v129
  v_lshlrev_b32 v20, 16, v130
  v_and_b32 v21, s92, v130
  v_lshlrev_b32 v22, 16, v131
  v_and_b32 v23, s92, v131
  v_fmac_f32_dpp v200, v7, v16 row_newbcast:10 row_mask:0xf bank_mask:0xf
  v_fmac_f32_dpp v201, v7, v17 row_newbcast:10 row_mask:0xf bank_mask:0xf
  v_fmac_f32_dpp v202, v7, v18 row_newbcast:10 row_mask:0xf bank_mask:0xf
  v_fmac_f32_dpp v203, v7, v19 row_newbcast:10 row_mask:0xf bank_mask:0xf
  v_fmac_f32_dpp v204, v7, v20 row_newbcast:10 row_mask:0xf bank_mask:0xf
  v_fmac_f32_dpp v205, v7, v21 row_newbcast:10 row_mask:0xf bank_mask:0xf
  v_fmac_f32_dpp v206, v7, v22 row_newbcast:10 row_mask:0xf bank_mask:0xf
  v_fmac_f32_dpp v207, v7, v23 row_newbcast:10 row_mask:0xf bank_mask:0xf
  s_waitcnt vmcnt(19)
  v_lshlrev_b32 v16, 16, v132
  v_and_b32 v17, s92, v132
  v_lshlrev_b32 v18, 16, v133
  v_and_b32 v19, s92, v133
  v_lshlrev_b32 v20, 16, v134
  v_and_b32 v21, s92, v134
  v_lshlrev_b32 v22, 16, v135
  v_and_b32 v23, s92, v135
  v_fmac_f32_dpp v200, v7, v16 row_newbcast:11 row_mask:0xf bank_mask:0xf
  v_fmac_f32_dpp v201, v7, v17 row_newbcast:11 row_mask:0xf bank_mask:0xf
  v_fmac_f32_dpp v202, v7, v18 row_newbcast:11 row_mask:0xf bank_mask:0xf
  v_fmac_f32_dpp v203, v7, v19 row_newbcast:11 row_mask:0xf bank_mask:0xf
  v_fmac_f32_dpp v204, v7, v20 row_newbcast:11 row_mask:0xf bank_mask:0xf
  v_fmac_f32_dpp v205, v7, v21 row_newbcast:11 row_mask:0xf bank_mask:0xf
  v_fmac_f32_dpp v206, v7, v22 row_newbcast:11 row_mask:0xf bank_mask:0xf
  v_fmac_f32_dpp v207, v7, v23 row_newbcast:11 row_mask:0xf bank_mask:0xf
  s_waitcnt vmcnt(18)
  v_lshlrev_b32 v16, 16, v136
  v_and_b32 v17, s92, v136
  v_lshlrev_b32 v18, 16, v137
  v_and_b32 v19, s92, v137
  v_lshlrev_b32 v20, 16, v138
  v_and_b32 v21, s92, v138
  v_lshlrev_b32 v22, 16, v139
  v_and_b32 v23, s92, v139
  v_fmac_f32_dpp v200, v7, v16 row_newbcast:12 row_mask:0xf bank_mask:0xf
  v_fmac_f32_dpp v201, v7, v17 row_newbcast:12 row_mask:0xf bank_mask:0xf
  v_fmac_f32_dpp v202, v7, v18 row_newbcast:12 row_mask:0xf bank_mask:0xf
  v_fmac_f32_dpp v203, v7, v19 row_newbcast:12 row_mask:0xf bank_mask:0xf
  v_fmac_f32_dpp v204, v7, v20 row_newbcast:12 row_mask:0xf bank_mask:0xf
  v_fmac_f32_dpp v205, v7, v21 row_newbcast:12 row_mask:0xf bank_mask:0xf
  v_fmac_f32_dpp v206, v7, v22 row_newbcast:12 row_mask:0xf bank_mask:0xf
  v_fmac_f32_dpp v207, v7, v23 row_newbcast:12 row_mask:0xf bank_mask:0xf
  s_waitcnt vmcnt(17)
  v_lshlrev_b32 v16, 16, v140
  v_and_b32 v17, s92, v140
  v_lshlrev_b32 v18, 16, v141
  v_and_b32 v19, s92, v141
  v_lshlrev_b32 v20, 16, v142
  v_and_b32 v21, s92, v142
  v_lshlrev_b32 v22, 16, v143
  v_and_b32 v23, s92, v143
  v_fmac_f32_dpp v200, v7, v16 row_newbcast:13 row_mask:0xf bank_mask:0xf
  v_fmac_f32_dpp v201, v7, v17 row_newbcast:13 row_mask:0xf bank_mask:0xf
  v_fmac_f32_dpp v202, v7, v18 row_newbcast:13 row_mask:0xf bank_mask:0xf
  v_fmac_f32_dpp v203, v7, v19 row_newbcast:13 row_mask:0xf bank_mask:0xf
  v_fmac_f32_dpp v204, v7, v20 row_newbcast:13 row_mask:0xf bank_mask:0xf
  v_fmac_f32_dpp v205, v7, v21 row_newbcast:13 row_mask:0xf bank_mask:0xf
  v_fmac_f32_dpp v206, v7, v22 row_newbcast:13 row_mask:0xf bank_mask:0xf
  v_fmac_f32_dpp v207, v7, v23 row_newbcast:13 row_mask:0xf bank_mask:0xf
  s_waitcnt vmcnt(16)
  v_lshlrev_b32 v16, 16, v144
  v_and_b32 v17, s92, v144
  v_lshlrev_b32 v18, 16, v145
  v_and_b32 v19, s92, v145
  v_lshlrev_b32 v20, 16, v146
  v_and_b32 v21, s92, v146
  v_lshlrev_b32 v22, 16, v147
  v_and_b32 v23, s92, v147
  v_fmac_f32_dpp v200, v7, v16 row_newbcast:14 row_mask:0xf bank_mask:0xf
  v_fmac_f32_dpp v201, v7, v17 row_newbcast:14 row_mask:0xf bank_mask:0xf
  v_fmac_f32_dpp v202, v7, v18 row_newbcast:14 row_mask:0xf bank_mask:0xf
  v_fmac_f32_dpp v203, v7, v19 row_newbcast:14 row_mask:0xf bank_mask:0xf
  v_fmac_f32_dpp v204, v7, v20 row_newbcast:14 row_mask:0xf bank_mask:0xf
  v_fmac_f32_dpp v205, v7, v21 row_newbcast:14 row_mask:0xf bank_mask:0xf
  v_fmac_f32_dpp v206, v7, v22 row_newbcast:14 row_mask:0xf bank_mask:0xf
  v_fmac_f32_dpp v207, v7, v23 row_newbcast:14 row_mask:0xf bank_mask:0xf
  s_waitcnt vmcnt(15)
  v_lshlrev_b32 v16, 16, v148
  v_and_b32 v17, s92, v148
  v_lshlrev_b32 v18, 16, v149
  v_and_b32 v19, s92, v149
  v_lshlrev_b32 v20, 16, v150
  v_and_b32 v21, s92, v150
  v_lshlrev_b32 v22, 16, v151
  v_and_b32 v23, s92, v151
  v_fmac_f32_dpp v200, v7, v16 row_newbcast:15 row_mask:0xf bank_mask:0xf
  v_fmac_f32_dpp v201, v7, v17 row_newbcast:15 row_mask:0xf bank_mask:0xf
  v_fmac_f32_dpp v202, v7, v18 row_newbcast:15 row_mask:0xf bank_mask:0xf
  v_fmac_f32_dpp v203, v7, v19 row_newbcast:15 row_mask:0xf bank_mask:0xf
  v_fmac_f32_dpp v204, v7, v20 row_newbcast:15 row_mask:0xf bank_mask:0xf
  v_fmac_f32_dpp v205, v7, v21 row_newbcast:15 row_mask:0xf bank_mask:0xf
  v_fmac_f32_dpp v206, v7, v22 row_newbcast:15 row_mask:0xf bank_mask:0xf
  v_fmac_f32_dpp v207, v7, v23 row_newbcast:15 row_mask:0xf bank_mask:0xf
  s_waitcnt vmcnt(14)
  v_lshlrev_b32 v16, 16, v152
  v_and_b32 v17, s92, v152
  v_lshlrev_b32 v18, 16, v153
  v_and_b32 v19, s92, v153
  v_lshlrev_b32 v20, 16, v154
  v_and_b32 v21, s92, v154
  v_lshlrev_b32 v22, 16, v155
  v_and_b32 v23, s92, v155
  v_fmac_f32_dpp v200, v8, v16 row_newbcast:0 row_mask:0xf bank_mask:0xf
  v_fmac_f32_dpp v201, v8, v17 row_newbcast:0 row_mask:0xf bank_mask:0xf
  v_fmac_f32_dpp v202, v8, v18 row_newbcast:0 row_mask:0xf bank_mask:0xf
  v_fmac_f32_dpp v203, v8, v19 row_newbcast:0 row_mask:0xf bank_mask:0xf
  v_fmac_f32_dpp v204, v8, v20 row_newbcast:0 row_mask:0xf bank_mask:0xf
  v_fmac_f32_dpp v205, v8, v21 row_newbcast:0 row_mask:0xf bank_mask:0xf
  v_fmac_f32_dpp v206, v8, v22 row_newbcast:0 row_mask:0xf bank_mask:0xf
  v_fmac_f32_dpp v207, v8, v23 row_newbcast:0 row_mask:0xf bank_mask:0xf
  s_waitcnt vmcnt(13)
  v_lshlrev_b32 v16, 16, v156
  v_and_b32 v17, s92, v156
  v_lshlrev_b32 v18, 16, v157
  v_and_b32 v19, s92, v157
  v_lshlrev_b32 v20, 16, v158
  v_and_b32 v21, s92, v158
  v_lshlrev_b32 v22, 16, v159
  v_and_b32 v23, s92, v159
  v_fmac_f32_dpp v200, v8, v16 row_newbcast:1 row_mask:0xf bank_mask:0xf
  v_fmac_f32_dpp v201, v8, v17 row_newbcast:1 row_mask:0xf bank_mask:0xf
  v_fmac_f32_dpp v202, v8, v18 row_newbcast:1 row_mask:0xf bank_mask:0xf
  v_fmac_f32_dpp v203, v8, v19 row_newbcast:1 row_mask:0xf bank_mask:0xf
  v_fmac_f32_dpp v204, v8, v20 row_newbcast:1 row_mask:0xf bank_mask:0xf
  v_fmac_f32_dpp v205, v8, v21 row_newbcast:1 row_mask:0xf bank_mask:0xf
  v_fmac_f32_dpp v206, v8, v22 row_newbcast:1 row_mask:0xf bank_mask:0xf
  v_fmac_f32_dpp v207, v8, v23 row_newbcast:1 row_mask:0xf bank_mask:0xf
  s_waitcnt vmcnt(12)
  v_lshlrev_b32 v16, 16, v160
  v_and_b32 v17, s92, v160
  v_lshlrev_b32 v18, 16, v161
  v_and_b32 v19, s92, v161
  v_lshlrev_b32 v20, 16, v162
  v_and_b32 v21, s92, v162
  v_lshlrev_b32 v22, 16, v163
  v_and_b32 v23, s92, v163
  v_fmac_f32_dpp v200, v8, v16 row_newbcast:2 row_mask:0xf bank_mask:0xf
  v_fmac_f32_dpp v201, v8, v17 row_newbcast:2 row_mask:0xf bank_mask:0xf
  v_fmac_f32_dpp v202, v8, v18 row_newbcast:2 row_mask:0xf bank_mask:0xf
  v_fmac_f32_dpp v203, v8, v19 row_newbcast:2 row_mask:0xf bank_mask:0xf
  v_fmac_f32_dpp v204, v8, v20 row_newbcast:2 row_mask:0xf bank_mask:0xf
  v_fmac_f32_dpp v205, v8, v21 row_newbcast:2 row_mask:0xf bank_mask:0xf
  v_fmac_f32_dpp v206, v8, v22 row_newbcast:2 row_mask:0xf bank_mask:0xf
  v_fmac_f32_dpp v207, v8, v23 row_newbcast:2 row_mask:0xf bank_mask:0xf
  s_waitcnt vmcnt(11)
  v_lshlrev_b32 v16, 16, v164
  v_and_b32 v17, s92, v164
  v_lshlrev_b32 v18, 16, v165
  v_and_b32 v19, s92, v165
  v_lshlrev_b32 v20, 16, v166
  v_and_b32 v21, s92, v166
  v_lshlrev_b32 v22, 16, v167
  v_and_b32 v23, s92, v167
  v_fmac_f32_dpp v200, v8, v16 row_newbcast:3 row_mask:0xf bank_mask:0xf
  v_fmac_f32_dpp v201, v8, v17 row_newbcast:3 row_mask:0xf bank_mask:0xf
  v_fmac_f32_dpp v202, v8, v18 row_newbcast:3 row_mask:0xf bank_mask:0xf
  v_fmac_f32_dpp v203, v8, v19 row_newbcast:3 row_mask:0xf bank_mask:0xf
  v_fmac_f32_dpp v204, v8, v20 row_newbcast:3 row_mask:0xf bank_mask:0xf
  v_fmac_f32_dpp v205, v8, v21 row_newbcast:3 row_mask:0xf bank_mask:0xf
  v_fmac_f32_dpp v206, v8, v22 row_newbcast:3 row_mask:0xf bank_mask:0xf
  v_fmac_f32_dpp v207, v8, v23 row_newbcast:3 row_mask:0xf bank_mask:0xf
  v_permlane32_swap_b32 v200, v204
  v_permlane32_swap_b32 v201, v205
  v_permlane32_swap_b32 v202, v206
  v_permlane32_swap_b32 v203, v207
  v_add_f32 v200, v200, v204
  v_add_f32 v201, v201, v205
  v_add_f32 v202, v202, v206
  v_add_f32 v203, v203, v207
  s_nop 0
  v_permlane16_swap_b32 v200, v202
  v_permlane16_swap_b32 v201, v203
  v_add_f32 v200, v200, v202
  v_add_f32 v201, v201, v203
  v_lshlrev_b32 v5, 5, v4
  v_lshl_add_u32 v5, v3, 3, v5
  s_lshl_b32 s7, s12, 9
  v_add_u32 v5, s7, v5
  ds_write_b64 v5, v[200:201] offset:0
  v_mov_b32 v1, 0
  v_mov_b32 v5, 20772
  ds_write_b32 v5, v1
  s_waitcnt lgkmcnt(0)
  s_barrier
  s_waitcnt vmcnt(0)
  v_lshlrev_b32 v200, 16, v232
  v_and_b32 v201, s92, v232
  v_lshlrev_b32 v202, 16, v233
  v_and_b32 v203, s92, v233
  v_lshlrev_b32 v204, 16, v234
  v_and_b32 v205, s92, v234
  v_lshlrev_b32 v206, 16, v235
  v_and_b32 v207, s92, v235
  v_lshlrev_b32 v208, 16, v236
  v_and_b32 v209, s92, v236
  v_add_f32 v16, v200, v201
  v_add_f32 v16, v16, v202
  v_add_f32 v16, v16, v203
  v_add_f32 v16, v16, v204
  v_add_f32 v16, v16, v205
  v_add_f32 v16, v16, v206
  v_add_f32 v16, v16, v207
  v_add_f32 v16, v16, v208
  v_add_f32 v16, v16, v209
  s_nop 1
  v_add_f32_dpp v16, v16, v16 row_ror:8 row_mask:0xf bank_mask:0xf
  s_nop 1
  v_add_f32_dpp v16, v16, v16 row_ror:4 row_mask:0xf bank_mask:0xf
  s_nop 1
  v_add_f32_dpp v16, v16, v16 row_ror:2 row_mask:0xf bank_mask:0xf
  s_nop 1
  v_add_f32_dpp v16, v16, v16 row_ror:1 row_mask:0xf bank_mask:0xf
  v_mov_b32 v17, v16
  s_nop 1
  v_permlane16_swap_b32 v16, v17
  v_add_f32 v16, v16, v17
  v_mov_b32 v17, v16
  s_nop 1
  v_permlane32_swap_b32 v16, v17
  v_add_f32 v16, v16, v17
  v_mul_f32 v16, 0x3ae38e39, v16
  v_sub_f32 v200, v200, v16
  v_sub_f32 v201, v201, v16
  v_sub_f32 v202, v202, v16
  v_sub_f32 v203, v203, v16
  v_sub_f32 v204, v204, v16
  v_sub_f32 v205, v205, v16
  v_sub_f32 v206, v206, v16
  v_sub_f32 v207, v207, v16
  v_sub_f32 v208, v208, v16
  v_sub_f32 v209, v209, v16
  v_cmp_gt_u32 vcc, 32, v0
  s_nop 1
  v_cndmask_b32 v208, 0, v208, vcc
  v_cndmask_b32 v209, 0, v209, vcc
  v_mul_f32 v16, v200, v200
  v_fmac_f32 v16, v201, v201
  v_fmac_f32 v16, v202, v202
  v_fmac_f32 v16, v203, v203
  v_fmac_f32 v16, v204, v204
  v_fmac_f32 v16, v205, v205
  v_fmac_f32 v16, v206, v206
  v_fmac_f32 v16, v207, v207
  v_fmac_f32 v16, v208, v208
  v_fmac_f32 v16, v209, v209
  s_nop 1
  v_add_f32_dpp v16, v16, v16 row_ror:8 row_mask:0xf bank_mask:0xf
  s_nop 1
  v_add_f32_dpp v16, v16, v16 row_ror:4 row_mask:0xf bank_mask:0xf
  s_nop 1
  v_add_f32_dpp v16, v16, v16 row_ror:2 row_mask:0xf bank_mask:0xf
  s_nop 1
  v_add_f32_dpp v16, v16, v16 row_ror:1 row_mask:0xf bank_mask:0xf
  v_mov_b32 v17, v16
  s_nop 1
  v_permlane16_swap_b32 v16, v17
  v_add_f32 v16, v16, v17
  v_mov_b32 v17, v16
  s_nop 1
  v_permlane32_swap_b32 v16, v17
  v_add_f32 v16, v16, v17
  v_mov_b32 v17, 0x3727c5ac
  v_fmac_f32 v17, 0x3ae38e39, v16
  v_rsq_f32 v17, v17
  s_nop 0
  v_mul_f32 v200, v200, v17
  v_mul_f32 v201, v201, v17
  v_mul_f32 v202, v202, v17
  v_mul_f32 v203, v203, v17
  v_mul_f32 v204, v204, v17
  v_mul_f32 v205, v205, v17
  v_mul_f32 v206, v206, v17
  v_mul_f32 v207, v207, v17
  v_mul_f32 v208, v208, v17
  v_mul_f32 v209, v209, v17
  v_lshlrev_b32 v1, 3, v0
  ds_write_b64 v1, v[200:201] offset:20832
  ds_write_b64 v1, v[202:203] offset:21344
  ds_write_b64 v1, v[204:205] offset:21856
  ds_write_b64 v1, v[206:207] offset:22368
  ds_write_b64 v1, v[208:209] offset:22880
  v_dot2_f32_bf16 v16, v232, v237, 0
  v_dot2_f32_bf16 v16, v233, v238, v16
  v_dot2_f32_bf16 v16, v234, v239, v16
  v_dot2_f32_bf16 v16, v235, v240, v16
  v_dot2_f32_bf16 v16, v236, v241, v16
  s_nop 2
  v_add_f32_dpp v16, v16, v16 row_ror:8 row_mask:0xf bank_mask:0xf
  s_nop 1
  v_add_f32_dpp v16, v16, v16 row_ror:4 row_mask:0xf bank_mask:0xf
  s_nop 1
  v_add_f32_dpp v16, v16, v16 row_ror:2 row_mask:0xf bank_mask:0xf
  s_nop 1
  v_add_f32_dpp v16, v16, v16 row_ror:1 row_mask:0xf bank_mask:0xf
  v_mov_b32 v17, v16
  s_nop 1
  v_permlane16_swap_b32 v16, v17
  v_add_f32 v16, v16, v17
  v_mov_b32 v17, v16
  s_nop 1
  v_permlane32_swap_b32 v16, v17
  v_add_f32 v16, v16, v17
  v_mul_f32 v16, 0xbfb8aa3b, v16
  v_exp_f32 v16, v16
  s_nop 0
  v_add_f32 v16, 1.0, v16
  v_rcp_f32 v246, v16
  s_nop 0
  v_sub_f32 v247, 1.0, v246
  v_mov_b32 v1, 20768
  ds_write_b32 v1, v246
  v_mul_u32_u24 v5, 57, v0
  v_lshrrev_b32 v5, 10, v5
  v_mul_u32_u24 v6, 18, v5
  v_sub_u32 v6, v0, v6
  v_mul_u32_u24 v7, 9216, v5
  v_lshl_add_u32 v7, v6, 4, v7
  s_mov_b32 s64, s28
  s_mov_b32 s65, s29
  s_mov_b32 s66, 5308416
  s_mov_b32 s67, 0x20000
  s_mul_i32 s10, s12, 1327104
  s_mul_i32 s11, s4, 288
  s_add_u32 s10, s10, s11
  s_mul_i32 s11, s12, 576
  v_lshl_add_u32 v1, v5, 2, s11
  buffer_load_dwordx4 v[168:171], v7, s[64:67], s10 offen
  s_add_u32 s10, s10, 27648
  buffer_load_dwordx4 v[172:175], v7, s[64:67], s10 offen
  s_add_u32 s10, s10, 27648
  v_mov_b32 v8, 0
  v_mov_b32 v9, 0
  v_mov_b32 v10, 0
  v_mov_b32 v11, 0
  v_mov_b32 v12, 0
  v_mov_b32 v13, 0
  v_mov_b32 v14, 0
  v_mov_b32 v15, 0
  s_mov_b32 s11, 0
  s_waitcnt lgkmcnt(0)
L_w1:
  ds_read_b32 v200, v1 offset:20832
  ds_read_b32 v201, v1 offset:20844
  v_add_u32 v1, 24, v1
  s_cmp_eq_u32 s11, 23
  s_cselect_b32 s10, 0x40000000, s10
  s_waitcnt lgkmcnt(0)
  s_waitcnt vmcnt(1)
  v_lshlrev_b32 v16, 16, v168
  v_and_b32 v17, s92, v168
  v_lshlrev_b32 v18, 16, v169
  v_and_b32 v19, s92, v169
  v_lshlrev_b32 v20, 16, v170
  v_and_b32 v21, s92, v170
  v_lshlrev_b32 v22, 16, v171
  v_and_b32 v23, s92, v171
  buffer_load_dwordx4 v[168:171], v7, s[64:67], s10 offen
  s_add_u32 s10, s10, 27648
  v_fmac_f32 v8, v200, v16
  v_fmac_f32 v9, v200, v17
  v_fmac_f32 v10, v200, v18
  v_fmac_f32 v11, v200, v19
  v_fmac_f32 v12, v200, v20
  v_fmac_f32 v13, v200, v21
  v_fmac_f32 v14, v200, v22
  v_fmac_f32 v15, v200, v23
  s_waitcnt vmcnt(1)
  v_lshlrev_b32 v16, 16, v172
  v_and_b32 v17, s92, v172
  v_lshlrev_b32 v18, 16, v173
  v_and_b32 v19, s92, v173
  v_lshlrev_b32 v20, 16, v174
  v_and_b32 v21, s92, v174
  v_lshlrev_b32 v22, 16, v175
  v_and_b32 v23, s92, v175
  buffer_load_dwordx4 v[172:175], v7, s[64:67], s10 offen
  s_add_u32 s10, s10, 27648
  v_fmac_f32 v8, v201, v16
  v_fmac_f32 v9, v201, v17
  v_fmac_f32 v10, v201, v18
  v_fmac_f32 v11, v201, v19
  v_fmac_f32 v12, v201, v20
  v_fmac_f32 v13, v201, v21
  v_fmac_f32 v14, v201, v22
  v_fmac_f32 v15, v201, v23
  s_add_u32 s11, s11, 1
  s_cmp_lt_u32 s11, 24
  s_cbranch_scc1 L_w1
  s_mul_i32 s11, s12, 3
  v_add_u32 v1, s11, v5
  v_mul_u32_u24 v1, 576, v1
  v_lshl_add_u32 v1, v6, 5, v1
  v_cmp_gt_u32 vcc, 54, v0
  s_and_saveexec_b64 s[10:11], vcc
  ds_write_b128 v1, v[8:11] offset:23392
  ds_write_b128 v1, v[12:15] offset:23408
  s_mov_b64 exec, 1
  v_mov_b32 v1, 20772
  v_mov_b32 v5, 1
  ds_add_u32 v1, v5
  s_mov_b64 exec, -1
  v_mov_b32 v1, 20772
  s_mov_b32 s93, 0
L_hspin:
  ds_read_b32 v5, v1
  s_waitcnt lgkmcnt(0)
  v_readfirstlane_b32 s10, v5
  s_cmp_ge_u32 s10, 4
  s_cbranch_scc1 L_hgo
  s_sleep 4
  s_add_u32 s93, s93, 1
  s_cmp_lt_u32 s93, 100000
  s_cbranch_scc1 L_hspin
L_hgo:
  s_mul_i32 s11, s12, 144
  v_min_u32 v1, 35, v0
  v_lshl_add_u32 v1, v1, 2, s11
  ds_read_b32 v200, v1 offset:23392
  ds_read_b32 v201, v1 offset:23968
  ds_read_b32 v202, v1 offset:24544
  ds_read_b32 v203, v1 offset:25120
  ds_read_b32 v204, v1 offset:25696
  ds_read_b32 v205, v1 offset:26272
  ds_read_b32 v206, v1 offset:26848
  ds_read_b32 v207, v1 offset:27424
  ds_read_b32 v208, v1 offset:28000
  ds_read_b32 v209, v1 offset:28576
  ds_read_b32 v210, v1 offset:29152
  ds_read_b32 v211, v1 offset:29728
  v_lshlrev_b32 v16, 16, v242
  s_waitcnt lgkmcnt(0)
  v_add_f32 v16, v16, v200
  v_add_f32 v16, v16, v201
  v_add_f32 v16, v16, v202
  v_add_f32 v16, v16, v203
  v_add_f32 v16, v16, v204
  v_add_f32 v16, v16, v205
  v_add_f32 v16, v16, v206
  v_add_f32 v16, v16, v207
  v_add_f32 v16, v16, v208
  v_add_f32 v16, v16, v209
  v_add_f32 v16, v16, v210
  v_add_f32 v16, v16, v211
  v_mul_f32 v17, v16, v16
  v_mov_b32 v18, 0xc0135761
  v_fmac_f32 v18, 0xbdd2d3e8, v17
  v_mul_f32 v18, v18, v16
  v_exp_f32 v18, v18
  s_nop 0
  v_add_f32 v18, 1.0, v18
  v_rcp_f32 v18, v18
  s_nop 0
  v_mul_f32 v16, v16, v18
  v_mul_f32 v16, v247, v16
  v_cmp_gt_u32 vcc, 36, v0
  s_nop 1
  v_cndmask_b32 v248, 0, v16, vcc
  s_mul_i32 s10, s4, 144
  s_mul_i32 s11, s12, 36
  s_add_u32 s10, s10, s11
  s_mul_i32 s10, s10, 1152
  s_add_u32 s72, s32, s10
  s_addc_u32 s73, s33, 0
  s_mov_b32 s74, 41472
  s_mov_b32 s75, 0x20000
  s_mov_b32 s10, 0
  buffer_load_dwordx4 v[168:171], v2, s[72:75], s10 offen
  s_addk_i32 s10, 1152
  buffer_load_dwordx4 v[172:175], v2, s[72:75], s10 offen
  s_addk_i32 s10, 1152
  s_mov_b32 s11, 0
L_w2:
  v_readlane_b32 s7, v248, s11
  s_add_u32 s11, s11, 1
  s_waitcnt vmcnt(1)
  v_lshlrev_b32 v16, 16, v168
  v_and_b32 v17, s92, v168
  v_lshlrev_b32 v18, 16, v169
  v_and_b32 v19, s92, v169
  v_lshlrev_b32 v20, 16, v170
  v_and_b32 v21, s92, v170
  v_lshlrev_b32 v22, 16, v171
  v_and_b32 v23, s92, v171
  buffer_load_dwordx4 v[168:171], v2, s[72:75], s10 offen
  s_addk_i32 s10, 1152
  v_fmac_f32 v216, s7, v16
  v_fmac_f32 v217, s7, v17
  v_fmac_f32 v218, s7, v18
  v_fmac_f32 v219, s7, v19
  v_fmac_f32 v220, s7, v20
  v_fmac_f32 v221, s7, v21
  v_fmac_f32 v222, s7, v22
  v_fmac_f32 v223, s7, v23
  v_readlane_b32 s7, v248, s11
  s_add_u32 s11, s11, 1
  s_waitcnt vmcnt(1)
  v_lshlrev_b32 v16, 16, v172
  v_and_b32 v17, s92, v172
  v_lshlrev_b32 v18, 16, v173
  v_and_b32 v19, s92, v173
  v_lshlrev_b32 v20, 16, v174
  v_and_b32 v21, s92, v174
  v_lshlrev_b32 v22, 16, v175
  v_and_b32 v23, s92, v175
  buffer_load_dwordx4 v[172:175], v2, s[72:75], s10 offen
  s_addk_i32 s10, 1152
  v_fmac_f32 v216, s7, v16
  v_fmac_f32 v217, s7, v17
  v_fmac_f32 v218, s7, v18
  v_fmac_f32 v219, s7, v19
  v_fmac_f32 v220, s7, v20
  v_fmac_f32 v221, s7, v21
  v_fmac_f32 v222, s7, v22
  v_fmac_f32 v223, s7, v23
  s_cmp_lt_u32 s11, 36
  s_cbranch_scc1 L_w2
  v_lshrrev_b32 v5, 3, v0
  v_mul_u32_u24 v6, 1152, v5
  v_and_b32 v1, 7, v0
  v_lshl_add_u32 v6, v1, 4, v6
  s_mov_b32 s10, 0
  buffer_load_dwordx4 v[24:27], v6, s[72:75], s10 offen offset:1024
  s_addk_i32 s10, 9216
  buffer_load_dwordx4 v[28:31], v6, s[72:75], s10 offen offset:1024
  s_addk_i32 s10, 9216
  buffer_load_dwordx4 v[32:35], v6, s[72:75], s10 offen offset:1024
  s_addk_i32 s10, 9216
  buffer_load_dwordx4 v[36:39], v6, s[72:75], s10 offen offset:1024
  s_addk_i32 s10, 9216
  buffer_load_dwordx4 v[40:43], v6, s[72:75], s10 offen offset:1024
  s_addk_i32 s10, 9216
  v_lshlrev_b32 v5, 2, v5
  ds_bpermute_b32 v200, v5, v248
  v_add_u32 v5, 32, v5
  ds_bpermute_b32 v201, v5, v248
  v_add_u32 v5, 32, v5
  ds_bpermute_b32 v202, v5, v248
  v_add_u32 v5, 32, v5
  ds_bpermute_b32 v203, v5, v248
  v_add_u32 v5, 32, v5
  ds_bpermute_b32 v204, v5, v248
  v_add_u32 v5, 32, v5
  s_waitcnt lgkmcnt(0)
  s_waitcnt vmcnt(4)
  v_lshlrev_b32 v16, 16, v24
  v_and_b32 v17, s92, v24
  v_lshlrev_b32 v18, 16, v25
  v_and_b32 v19, s92, v25
  v_lshlrev_b32 v20, 16, v26
  v_and_b32 v21, s92, v26
  v_lshlrev_b32 v22, 16, v27
  v_and_b32 v23, s92, v27
  v_fmac_f32 v224, v200, v16
  v_fmac_f32 v225, v200, v17
  v_fmac_f32 v226, v200, v18
  v_fmac_f32 v227, v200, v19
  v_fmac_f32 v228, v200, v20
  v_fmac_f32 v229, v200, v21
  v_fmac_f32 v230, v200, v22
  v_fmac_f32 v231, v200, v23
  s_waitcnt vmcnt(3)
  v_lshlrev_b32 v16, 16, v28
  v_and_b32 v17, s92, v28
  v_lshlrev_b32 v18, 16, v29
  v_and_b32 v19, s92, v29
  v_lshlrev_b32 v20, 16, v30
  v_and_b32 v21, s92, v30
  v_lshlrev_b32 v22, 16, v31
  v_and_b32 v23, s92, v31
  v_fmac_f32 v224, v201, v16
  v_fmac_f32 v225, v201, v17
  v_fmac_f32 v226, v201, v18
  v_fmac_f32 v227, v201, v19
  v_fmac_f32 v228, v201, v20
  v_fmac_f32 v229, v201, v21
  v_fmac_f32 v230, v201, v22
  v_fmac_f32 v231, v201, v23
  s_waitcnt vmcnt(2)
  v_lshlrev_b32 v16, 16, v32
  v_and_b32 v17, s92, v32
  v_lshlrev_b32 v18, 16, v33
  v_and_b32 v19, s92, v33
  v_lshlrev_b32 v20, 16, v34
  v_and_b32 v21, s92, v34
  v_lshlrev_b32 v22, 16, v35
  v_and_b32 v23, s92, v35
  v_fmac_f32 v224, v202, v16
  v_fmac_f32 v225, v202, v17
  v_fmac_f32 v226, v202, v18
  v_fmac_f32 v227, v202, v19
  v_fmac_f32 v228, v202, v20
  v_fmac_f32 v229, v202, v21
  v_fmac_f32 v230, v202, v22
  v_fmac_f32 v231, v202, v23
  s_waitcnt vmcnt(1)
  v_lshlrev_b32 v16, 16, v36
  v_and_b32 v17, s92, v36
  v_lshlrev_b32 v18, 16, v37
  v_and_b32 v19, s92, v37
  v_lshlrev_b32 v20, 16, v38
  v_and_b32 v21, s92, v38
  v_lshlrev_b32 v22, 16, v39
  v_and_b32 v23, s92, v39
  v_fmac_f32 v224, v203, v16
  v_fmac_f32 v225, v203, v17
  v_fmac_f32 v226, v203, v18
  v_fmac_f32 v227, v203, v19
  v_fmac_f32 v228, v203, v20
  v_fmac_f32 v229, v203, v21
  v_fmac_f32 v230, v203, v22
  v_fmac_f32 v231, v203, v23
  s_waitcnt vmcnt(0)
  v_lshlrev_b32 v16, 16, v40
  v_and_b32 v17, s92, v40
  v_lshlrev_b32 v18, 16, v41
  v_and_b32 v19, s92, v41
  v_lshlrev_b32 v20, 16, v42
  v_and_b32 v21, s92, v42
  v_lshlrev_b32 v22, 16, v43
  v_and_b32 v23, s92, v43
  v_fmac_f32 v224, v204, v16
  v_fmac_f32 v225, v204, v17
  v_fmac_f32 v226, v204, v18
  v_fmac_f32 v227, v204, v19
  v_fmac_f32 v228, v204, v20
  v_fmac_f32 v229, v204, v21
  v_fmac_f32 v230, v204, v22
  v_fmac_f32 v231, v204, v23
  s_lshl_b32 s10, s4, 7
  s_lshl_b32 s11, s12, 5
  s_add_u32 s10, s10, s11
  s_mul_i32 s10, s10, 1152
  v_lshrrev_b32 v5, 3, v0
  v_mul_u32_u24 v5, 2304, v5
  v_and_b32 v1, 7, v0
  v_lshl_add_u32 v5, v1, 4, v5
  buffer_load_dwordx4 v[152:155], v5, s[76:79], s10 offen offset:1024
  buffer_load_dwordx4 v[156:159], v5, s[76:79], s10 offen offset:2176
  s_add_u32 s11, s10, 18432
  s_mov_b32 s7, s10
  s_mov_b32 s10, s11
  buffer_load_dwordx4 v[160:163], v5, s[76:79], s10 offen offset:1024
  buffer_load_dwordx4 v[164:167], v5, s[76:79], s10 offen offset:2176
  s_mov_b32 s10, s7
  s_waitcnt vmcnt(3)
  buffer_load_dwordx4 v[24:27], v2, s[76:79], s10 offen
  s_addk_i32 s10, 1152
  s_waitcnt vmcnt(3)
  buffer_load_dwordx4 v[28:31], v2, s[76:79], s10 offen
  s_addk_i32 s10, 1152
  s_waitcnt vmcnt(3)
  buffer_load_dwordx4 v[32:35], v2, s[76:79], s10 offen
  s_addk_i32 s10, 1152
  s_waitcnt vmcnt(3)
  buffer_load_dwordx4 v[36:39], v2, s[76:79], s10 offen
  s_addk_i32 s10, 1152
  s_waitcnt vmcnt(3)
  buffer_load_dwordx4 v[40:43], v2, s[76:79], s10 offen
  s_addk_i32 s10, 1152
  s_waitcnt vmcnt(3)
  buffer_load_dwordx4 v[44:47], v2, s[76:79], s10 offen
  s_addk_i32 s10, 1152
  s_waitcnt vmcnt(3)
  buffer_load_dwordx4 v[48:51], v2, s[76:79], s10 offen
  s_addk_i32 s10, 1152
  s_waitcnt vmcnt(3)
  buffer_load_dwordx4 v[52:55], v2, s[76:79], s10 offen
  s_addk_i32 s10, 1152
  s_waitcnt vmcnt(3)
  buffer_load_dwordx4 v[56:59], v2, s[76:79], s10 offen
  s_addk_i32 s10, 1152
  s_waitcnt vmcnt(3)
  buffer_load_dwordx4 v[60:63], v2, s[76:79], s10 offen
  s_addk_i32 s10, 1152
  s_waitcnt vmcnt(3)
  buffer_load_dwordx4 v[64:67], v2, s[76:79], s10 offen
  s_addk_i32 s10, 1152
  s_waitcnt vmcnt(3)
  buffer_load_dwordx4 v[68:71], v2, s[76:79], s10 offen
  s_addk_i32 s10, 1152
  s_waitcnt vmcnt(3)
  buffer_load_dwordx4 v[72:75], v2, s[76:79], s10 offen
  s_addk_i32 s10, 1152
  s_waitcnt vmcnt(3)
  buffer_load_dwordx4 v[76:79], v2, s[76:79], s10 offen
  s_addk_i32 s10, 1152
  s_waitcnt vmcnt(3)
  buffer_load_dwordx4 v[80:83], v2, s[76:79], s10 offen
  s_addk_i32 s10, 1152
  s_waitcnt vmcnt(3)
  buffer_load_dwordx4 v[84:87], v2, s[76:79], s10 offen
  s_addk_i32 s10, 1152
  s_waitcnt vmcnt(3)
  buffer_load_dwordx4 v[88:91], v2, s[76:79], s10 offen
  s_addk_i32 s10, 1152
  s_waitcnt vmcnt(3)
  buffer_load_dwordx4 v[92:95], v2, s[76:79], s10 offen
  s_addk_i32 s10, 1152
  s_waitcnt vmcnt(3)
  buffer_load_dwordx4 v[96:99], v2, s[76:79], s10 offen
  s_addk_i32 s10, 1152
  s_waitcnt vmcnt(3)
  buffer_load_dwordx4 v[100:103], v2, s[76:79], s10 offen
  s_addk_i32 s10, 1152
  s_waitcnt vmcnt(3)
  buffer_load_dwordx4 v[104:107], v2, s[76:79], s10 offen
  s_addk_i32 s10, 1152
  s_waitcnt vmcnt(3)
  buffer_load_dwordx4 v[108:111], v2, s[76:79], s10 offen
  s_addk_i32 s10, 1152
  s_waitcnt vmcnt(3)
  buffer_load_dwordx4 v[112:115], v2, s[76:79], s10 offen
  s_addk_i32 s10, 1152
  s_waitcnt vmcnt(3)
  buffer_load_dwordx4 v[116:119], v2, s[76:79], s10 offen
  s_addk_i32 s10, 1152
  s_waitcnt vmcnt(3)
  buffer_load_dwordx4 v[120:123], v2, s[76:79], s10 offen
  s_addk_i32 s10, 1152
  s_waitcnt vmcnt(3)
  buffer_load_dwordx4 v[124:127], v2, s[76:79], s10 offen
  s_addk_i32 s10, 1152
  s_waitcnt vmcnt(3)
  buffer_load_dwordx4 v[128:131], v2, s[76:79], s10 offen
  s_addk_i32 s10, 1152
  s_waitcnt vmcnt(3)
  buffer_load_dwordx4 v[132:135], v2, s[76:79], s10 offen
  s_addk_i32 s10, 1152
  s_waitcnt vmcnt(3)
  buffer_load_dwordx4 v[136:139], v2, s[76:79], s10 offen
  s_addk_i32 s10, 1152
  s_waitcnt vmcnt(3)
  buffer_load_dwordx4 v[140:143], v2, s[76:79], s10 offen
  s_addk_i32 s10, 1152
  s_waitcnt vmcnt(3)
  buffer_load_dwordx4 v[144:147], v2, s[76:79], s10 offen
  s_addk_i32 s10, 1152
  s_waitcnt vmcnt(3)
  buffer_load_dwordx4 v[148:151], v2, s[76:79], s10 offen
  s_addk_i32 s10, 1152
L_rdy0:
  s_mov_b32 s10, 0x05040100
  s_mov_b32 s11, 0x07060302
  s_waitcnt vmcnt(0)
  v_perm_b32 v16, v28, v24, s10
  v_perm_b32 v28, v28, v24, s11
  v_mov_b32 v24, v16
  v_perm_b32 v17, v29, v25, s10
  v_perm_b32 v29, v29, v25, s11
  v_mov_b32 v25, v17
  v_perm_b32 v18, v30, v26, s10
  v_perm_b32 v30, v30, v26, s11
  v_mov_b32 v26, v18
  v_perm_b32 v19, v31, v27, s10
  v_perm_b32 v31, v31, v27, s11
  v_mov_b32 v27, v19
  v_perm_b32 v16, v36, v32, s10
  v_perm_b32 v36, v36, v32, s11
  v_mov_b32 v32, v16
  v_perm_b32 v17, v37, v33, s10
  v_perm_b32 v37, v37, v33, s11
  v_mov_b32 v33, v17
  v_perm_b32 v18, v38, v34, s10
  v_perm_b32 v38, v38, v34, s11
  v_mov_b32 v34, v18
  v_perm_b32 v19, v39, v35, s10
  v_perm_b32 v39, v39, v35, s11
  v_mov_b32 v35, v19
  v_perm_b32 v16, v44, v40, s10
  v_perm_b32 v44, v44, v40, s11
  v_mov_b32 v40, v16
  v_perm_b32 v17, v45, v41, s10
  v_perm_b32 v45, v45, v41, s11
  v_mov_b32 v41, v17
  v_perm_b32 v18, v46, v42, s10
  v_perm_b32 v46, v46, v42, s11
  v_mov_b32 v42, v18
  v_perm_b32 v19, v47, v43, s10
  v_perm_b32 v47, v47, v43, s11
  v_mov_b32 v43, v19
  v_perm_b32 v16, v52, v48, s10
  v_perm_b32 v52, v52, v48, s11
  v_mov_b32 v48, v16
  v_perm_b32 v17, v53, v49, s10
  v_perm_b32 v53, v53, v49, s11
  v_mov_b32 v49, v17
  v_perm_b32 v18, v54, v50, s10
  v_perm_b32 v54, v54, v50, s11
  v_mov_b32 v50, v18
  v_perm_b32 v19, v55, v51, s10
  v_perm_b32 v55, v55, v51, s11
  v_mov_b32 v51, v19
  v_perm_b32 v16, v60, v56, s10
  v_perm_b32 v60, v60, v56, s11
  v_mov_b32 v56, v16
  v_perm_b32 v17, v61, v57, s10
  v_perm_b32 v61, v61, v57, s11
  v_mov_b32 v57, v17
  v_perm_b32 v18, v62, v58, s10
  v_perm_b32 v62, v62, v58, s11
  v_mov_b32 v58, v18
  v_perm_b32 v19, v63, v59, s10
  v_perm_b32 v63, v63, v59, s11
  v_mov_b32 v59, v19
  v_perm_b32 v16, v68, v64, s10
  v_perm_b32 v68, v68, v64, s11
  v_mov_b32 v64, v16
  v_perm_b32 v17, v69, v65, s10
  v_perm_b32 v69, v69, v65, s11
  v_mov_b32 v65, v17
  v_perm_b32 v18, v70, v66, s10
  v_perm_b32 v70, v70, v66, s11
  v_mov_b32 v66, v18
  v_perm_b32 v19, v71, v67, s10
  v_perm_b32 v71, v71, v67, s11
  v_mov_b32 v67, v19
  v_perm_b32 v16, v76, v72, s10
  v_perm_b32 v76, v76, v72, s11
  v_mov_b32 v72, v16
  v_perm_b32 v17, v77, v73, s10
  v_perm_b32 v77, v77, v73, s11
  v_mov_b32 v73, v17
  v_perm_b32 v18, v78, v74, s10
  v_perm_b32 v78, v78, v74, s11
  v_mov_b32 v74, v18
  v_perm_b32 v19, v79, v75, s10
  v_perm_b32 v79, v79, v75, s11
  v_mov_b32 v75, v19
  v_perm_b32 v16, v84, v80, s10
  v_perm_b32 v84, v84, v80, s11
  v_mov_b32 v80, v16
  v_perm_b32 v17, v85, v81, s10
  v_perm_b32 v85, v85, v81, s11
  v_mov_b32 v81, v17
  v_perm_b32 v18, v86, v82, s10
  v_perm_b32 v86, v86, v82, s11
  v_mov_b32 v82, v18
  v_perm_b32 v19, v87, v83, s10
  v_perm_b32 v87, v87, v83, s11
  v_mov_b32 v83, v19
  v_perm_b32 v16, v92, v88, s10
  v_perm_b32 v92, v92, v88, s11
  v_mov_b32 v88, v16
  v_perm_b32 v17, v93, v89, s10
  v_perm_b32 v93, v93, v89, s11
  v_mov_b32 v89, v17
  v_perm_b32 v18, v94, v90, s10
  v_perm_b32 v94, v94, v90, s11
  v_mov_b32 v90, v18
  v_perm_b32 v19, v95, v91, s10
  v_perm_b32 v95, v95, v91, s11
  v_mov_b32 v91, v19
  v_perm_b32 v16, v100, v96, s10
  v_perm_b32 v100, v100, v96, s11
  v_mov_b32 v96, v16
  v_perm_b32 v17, v101, v97, s10
  v_perm_b32 v101, v101, v97, s11
  v_mov_b32 v97, v17
  v_perm_b32 v18, v102, v98, s10
  v_perm_b32 v102, v102, v98, s11
  v_mov_b32 v98, v18
  v_perm_b32 v19, v103, v99, s10
  v_perm_b32 v103, v103, v99, s11
  v_mov_b32 v99, v19
  v_perm_b32 v16, v108, v104, s10
  v_perm_b32 v108, v108, v104, s11
  v_mov_b32 v104, v16
  v_perm_b32 v17, v109, v105, s10
  v_perm_b32 v109, v109, v105, s11
  v_mov_b32 v105, v17
  v_perm_b32 v18, v110, v106, s10
  v_perm_b32 v110, v110, v106, s11
  v_mov_b32 v106, v18
  v_perm_b32 v19, v111, v107, s10
  v_perm_b32 v111, v111, v107, s11
  v_mov_b32 v107, v19
  v_perm_b32 v16, v116, v112, s10
  v_perm_b32 v116, v116, v112, s11
  v_mov_b32 v112, v16
  v_perm_b32 v17, v117, v113, s10
  v_perm_b32 v117, v117, v113, s11
  v_mov_b32 v113, v17
  v_perm_b32 v18, v118, v114, s10
  v_perm_b32 v118, v118, v114, s11
  v_mov_b32 v114, v18
  v_perm_b32 v19, v119, v115, s10
  v_perm_b32 v119, v119, v115, s11
  v_mov_b32 v115, v19
  v_perm_b32 v16, v124, v120, s10
  v_perm_b32 v124, v124, v120, s11
  v_mov_b32 v120, v16
  v_perm_b32 v17, v125, v121, s10
  v_perm_b32 v125, v125, v121, s11
  v_mov_b32 v121, v17
  v_perm_b32 v18, v126, v122, s10
  v_perm_b32 v126, v126, v122, s11
  v_mov_b32 v122, v18
  v_perm_b32 v19, v127, v123, s10
  v_perm_b32 v127, v127, v123, s11
  v_mov_b32 v123, v19
  v_perm_b32 v16, v132, v128, s10
  v_perm_b32 v132, v132, v128, s11
  v_mov_b32 v128, v16
  v_perm_b32 v17, v133, v129, s10
  v_perm_b32 v133, v133, v129, s11
  v_mov_b32 v129, v17
  v_perm_b32 v18, v134, v130, s10
  v_perm_b32 v134, v134, v130, s11
  v_mov_b32 v130, v18
  v_perm_b32 v19, v135, v131, s10
  v_perm_b32 v135, v135, v131, s11
  v_mov_b32 v131, v19
  v_perm_b32 v16, v140, v136, s10
  v_perm_b32 v140, v140, v136, s11
  v_mov_b32 v136, v16
  v_perm_b32 v17, v141, v137, s10
  v_perm_b32 v141, v141, v137, s11
  v_mov_b32 v137, v17
  v_perm_b32 v18, v142, v138, s10
  v_perm_b32 v142, v142, v138, s11
  v_mov_b32 v138, v18
  v_perm_b32 v19, v143, v139, s10
  v_perm_b32 v143, v143, v139, s11
  v_mov_b32 v139, v19
  v_perm_b32 v16, v148, v144, s10
  v_perm_b32 v148, v148, v144, s11
  v_mov_b32 v144, v16
  v_perm_b32 v17, v149, v145, s10
  v_perm_b32 v149, v149, v145, s11
  v_mov_b32 v145, v17
  v_perm_b32 v18, v150, v146, s10
  v_perm_b32 v150, v150, v146, s11
  v_mov_b32 v146, v18
  v_perm_b32 v19, v151, v147, s10
  v_perm_b32 v151, v151, v147, s11
  v_mov_b32 v147, v19
  v_perm_b32 v16, v156, v152, s10
  v_perm_b32 v156, v156, v152, s11
  v_mov_b32 v152, v16
  v_perm_b32 v17, v157, v153, s10
  v_perm_b32 v157, v157, v153, s11
  v_mov_b32 v153, v17
  v_perm_b32 v18, v158, v154, s10
  v_perm_b32 v158, v158, v154, s11
  v_mov_b32 v154, v18
  v_perm_b32 v19, v159, v155, s10
  v_perm_b32 v159, v159, v155, s11
  v_mov_b32 v155, v19
  v_perm_b32 v16, v164, v160, s10
  v_perm_b32 v164, v164, v160, s11
  v_mov_b32 v160, v16
  v_perm_b32 v17, v165, v161, s10
  v_perm_b32 v165, v165, v161, s11
  v_mov_b32 v161, v17
  v_perm_b32 v18, v166, v162, s10
  v_perm_b32 v166, v166, v162, s11
  v_mov_b32 v162, v18
  v_perm_b32 v19, v167, v163, s10
  v_perm_b32 v167, v167, v163, s11
  v_mov_b32 v163, v19
  s_lshl_b32 s7, s12, 7
  v_lshlrev_b32 v1, 9, v3
  v_lshl_add_u32 v1, v4, 2, v1
  v_add_u32 v1, s7, v1
  v_mov_b32 v5, 0
  v_lshlrev_b32 v6, 3, v3
  v_lshrrev_b32 v7, 3, v0
  v_lshlrev_b32 v7, 3, v7
  s_mul_i32 s9, s12, 2304
  v_lshl_add_u32 v8, v0, 5, s9
  v_and_b32 v9, 7, v0
  v_lshlrev_b32 v9, 3, v9
  v_bfe_u32 v10, v0, 3, 1
  v_add_u32 v9, v9, v10
  v_lshl_add_u32 v9, v3, 1, v9
  v_lshl_add_u32 v9, v9, 2, s9
  s_barrier
  ds_read_b32 v16, v1 offset:2048
  ds_read_b32 v20, v1 offset:2112
  ds_read_b128 v[200:203], v5 offset:20736
  ds_read_b128 v[204:207], v5 offset:20752
  ds_read_b32 v17, v6 offset:20736
  s_waitcnt lgkmcnt(0)
  v_max3_f32 v18, v200, v202, v204
  v_max_f32 v18, v18, v206
  v_sub_f32 v200, v200, v18
  v_sub_f32 v202, v202, v18
  v_sub_f32 v204, v204, v18
  v_sub_f32 v206, v206, v18
  v_sub_f32 v17, v17, v18
  v_exp_f32 v200, v200
  v_exp_f32 v202, v202
  v_exp_f32 v204, v204
  v_exp_f32 v206, v206
  v_exp_f32 v17, v17
  v_mul_f32 v19, v200, v201
  v_fmac_f32 v19, v202, v203
  v_fmac_f32 v19, v204, v205
  v_fmac_f32 v19, v206, v207
  v_rcp_f32 v19, v19
  v_mul_f32 v16, v16, v17
  v_mul_f32 v20, v20, v17
  v_mul_f32 v19, v19, v246
  s_nop 0
  v_permlane32_swap_b32 v16, v20
  v_add_f32 v16, v16, v20
  v_mov_b32 v17, v16
  s_nop 1
  v_permlane16_swap_b32 v16, v17
  v_add_f32 v16, v16, v17
  v_mul_f32 v16, v16, v19
  s_nop 1
  v_mov_b32_dpp v17, v16 quad_perm:[1,0,3,2] row_mask:0xf bank_mask:0xf
  v_cvt_pk_bf16_f32 v16, v16, v17
  ds_bpermute_b32 v18, v7, v16
  v_add_u32 v7, 128, v7
  ds_bpermute_b32 v19, v7, v16
  v_readlane_b32 s60, v16, 0
  v_readlane_b32 s61, v16, 2
  v_readlane_b32 s62, v16, 4
  v_readlane_b32 s63, v16, 6
  v_readlane_b32 s64, v16, 8
  v_readlane_b32 s65, v16, 10
  v_readlane_b32 s66, v16, 12
  v_readlane_b32 s67, v16, 14
  v_readlane_b32 s68, v16, 32
  v_readlane_b32 s69, v16, 34
  v_readlane_b32 s70, v16, 36
  v_readlane_b32 s71, v16, 38
  v_readlane_b32 s72, v16, 40
  v_readlane_b32 s73, v16, 42
  v_readlane_b32 s74, v16, 44
  v_readlane_b32 s75, v16, 46
  v_dot2c_f32_bf16 v216, s60, v24
  v_dot2c_f32_bf16 v217, s60, v28
  v_dot2c_f32_bf16 v218, s60, v25
  v_dot2c_f32_bf16 v219, s60, v29
  v_dot2c_f32_bf16 v220, s60, v26
  v_dot2c_f32_bf16 v221, s60, v30
  v_dot2c_f32_bf16 v222, s60, v27
  v_dot2c_f32_bf16 v223, s60, v31
  v_dot2c_f32_bf16 v216, s61, v32
  v_dot2c_f32_bf16 v217, s61, v36
  v_dot2c_f32_bf16 v218, s61, v33
  v_dot2c_f32_bf16 v219, s61, v37
  v_dot2c_f32_bf16 v220, s61, v34
  v_dot2c_f32_bf16 v221, s61, v38
  v_dot2c_f32_bf16 v222, s61, v35
  v_dot2c_f32_bf16 v223, s61, v39
  v_dot2c_f32_bf16 v216, s62, v40
  v_dot2c_f32_bf16 v217, s62, v44
  v_dot2c_f32_bf16 v218, s62, v41
  v_dot2c_f32_bf16 v219, s62, v45
  v_dot2c_f32_bf16 v220, s62, v42
  v_dot2c_f32_bf16 v221, s62, v46
  v_dot2c_f32_bf16 v222, s62, v43
  v_dot2c_f32_bf16 v223, s62, v47
  v_dot2c_f32_bf16 v216, s63, v48
  v_dot2c_f32_bf16 v217, s63, v52
  v_dot2c_f32_bf16 v218, s63, v49
  v_dot2c_f32_bf16 v219, s63, v53
  v_dot2c_f32_bf16 v220, s63, v50
  v_dot2c_f32_bf16 v221, s63, v54
  v_dot2c_f32_bf16 v222, s63, v51
  v_dot2c_f32_bf16 v223, s63, v55
  v_dot2c_f32_bf16 v216, s64, v56
  v_dot2c_f32_bf16 v217, s64, v60
  v_dot2c_f32_bf16 v218, s64, v57
  v_dot2c_f32_bf16 v219, s64, v61
  v_dot2c_f32_bf16 v220, s64, v58
  v_dot2c_f32_bf16 v221, s64, v62
  v_dot2c_f32_bf16 v222, s64, v59
  v_dot2c_f32_bf16 v223, s64, v63
  v_dot2c_f32_bf16 v216, s65, v64
  v_dot2c_f32_bf16 v217, s65, v68
  v_dot2c_f32_bf16 v218, s65, v65
  v_dot2c_f32_bf16 v219, s65, v69
  v_dot2c_f32_bf16 v220, s65, v66
  v_dot2c_f32_bf16 v221, s65, v70
  v_dot2c_f32_bf16 v222, s65, v67
  v_dot2c_f32_bf16 v223, s65, v71
  v_dot2c_f32_bf16 v216, s66, v72
  v_dot2c_f32_bf16 v217, s66, v76
  v_dot2c_f32_bf16 v218, s66, v73
  v_dot2c_f32_bf16 v219, s66, v77
  v_dot2c_f32_bf16 v220, s66, v74
  v_dot2c_f32_bf16 v221, s66, v78
  v_dot2c_f32_bf16 v222, s66, v75
  v_dot2c_f32_bf16 v223, s66, v79
  v_dot2c_f32_bf16 v216, s67, v80
  v_dot2c_f32_bf16 v217, s67, v84
  v_dot2c_f32_bf16 v218, s67, v81
  v_dot2c_f32_bf16 v219, s67, v85
  v_dot2c_f32_bf16 v220, s67, v82
  v_dot2c_f32_bf16 v221, s67, v86
  v_dot2c_f32_bf16 v222, s67, v83
  v_dot2c_f32_bf16 v223, s67, v87
  v_dot2c_f32_bf16 v216, s68, v88
  v_dot2c_f32_bf16 v217, s68, v92
  v_dot2c_f32_bf16 v218, s68, v89
  v_dot2c_f32_bf16 v219, s68, v93
  v_dot2c_f32_bf16 v220, s68, v90
  v_dot2c_f32_bf16 v221, s68, v94
  v_dot2c_f32_bf16 v222, s68, v91
  v_dot2c_f32_bf16 v223, s68, v95
  v_dot2c_f32_bf16 v216, s69, v96
  v_dot2c_f32_bf16 v217, s69, v100
  v_dot2c_f32_bf16 v218, s69, v97
  v_dot2c_f32_bf16 v219, s69, v101
  v_dot2c_f32_bf16 v220, s69, v98
  v_dot2c_f32_bf16 v221, s69, v102
  v_dot2c_f32_bf16 v222, s69, v99
  v_dot2c_f32_bf16 v223, s69, v103
  v_dot2c_f32_bf16 v216, s70, v104
  v_dot2c_f32_bf16 v217, s70, v108
  v_dot2c_f32_bf16 v218, s70, v105
  v_dot2c_f32_bf16 v219, s70, v109
  v_dot2c_f32_bf16 v220, s70, v106
  v_dot2c_f32_bf16 v221, s70, v110
  v_dot2c_f32_bf16 v222, s70, v107
  v_dot2c_f32_bf16 v223, s70, v111
  v_dot2c_f32_bf16 v216, s71, v112
  v_dot2c_f32_bf16 v217, s71, v116
  v_dot2c_f32_bf16 v218, s71, v113
  v_dot2c_f32_bf16 v219, s71, v117
  v_dot2c_f32_bf16 v220, s71, v114
  v_dot2c_f32_bf16 v221, s71, v118
  v_dot2c_f32_bf16 v222, s71, v115
  v_dot2c_f32_bf16 v223, s71, v119
  v_dot2c_f32_bf16 v216, s72, v120
  v_dot2c_f32_bf16 v217, s72, v124
  v_dot2c_f32_bf16 v218, s72, v121
  v_dot2c_f32_bf16 v219, s72, v125
  v_dot2c_f32_bf16 v220, s72, v122
  v_dot2c_f32_bf16 v221, s72, v126
  v_dot2c_f32_bf16 v222, s72, v123
  v_dot2c_f32_bf16 v223, s72, v127
  v_dot2c_f32_bf16 v216, s73, v128
  v_dot2c_f32_bf16 v217, s73, v132
  v_dot2c_f32_bf16 v218, s73, v129
  v_dot2c_f32_bf16 v219, s73, v133
  v_dot2c_f32_bf16 v220, s73, v130
  v_dot2c_f32_bf16 v221, s73, v134
  v_dot2c_f32_bf16 v222, s73, v131
  v_dot2c_f32_bf16 v223, s73, v135
  v_dot2c_f32_bf16 v216, s74, v136
  v_dot2c_f32_bf16 v217, s74, v140
  v_dot2c_f32_bf16 v218, s74, v137
  v_dot2c_f32_bf16 v219, s74, v141
  v_dot2c_f32_bf16 v220, s74, v138
  v_dot2c_f32_bf16 v221, s74, v142
  v_dot2c_f32_bf16 v222, s74, v139
  v_dot2c_f32_bf16 v223, s74, v143
  v_dot2c_f32_bf16 v216, s75, v144
  v_dot2c_f32_bf16 v217, s75, v148
  v_dot2c_f32_bf16 v218, s75, v145
  v_dot2c_f32_bf16 v219, s75, v149
  v_dot2c_f32_bf16 v220, s75, v146
  v_dot2c_f32_bf16 v221, s75, v150
  v_dot2c_f32_bf16 v222, s75, v147
  v_dot2c_f32_bf16 v223, s75, v151
  ds_write_b128 v8, v[216:219] offset:30304
  s_nop 1
  ds_write_b128 v8, v[220:223] offset:30320
  s_waitcnt lgkmcnt(2)
  v_dot2c_f32_bf16 v224, v18, v152
  v_dot2c_f32_bf16 v225, v18, v156
  v_dot2c_f32_bf16 v226, v18, v153
  v_dot2c_f32_bf16 v227, v18, v157
  v_dot2c_f32_bf16 v228, v18, v154
  v_dot2c_f32_bf16 v229, v18, v158
  v_dot2c_f32_bf16 v230, v18, v155
  v_dot2c_f32_bf16 v231, v18, v159
  v_dot2c_f32_bf16 v224, v19, v160
  v_dot2c_f32_bf16 v225, v19, v164
  v_dot2c_f32_bf16 v226, v19, v161
  v_dot2c_f32_bf16 v227, v19, v165
  v_dot2c_f32_bf16 v228, v19, v162
  v_dot2c_f32_bf16 v229, v19, v166
  v_dot2c_f32_bf16 v230, v19, v163
  v_dot2c_f32_bf16 v231, v19, v167
  v_permlane32_swap_b32 v224, v228
  v_permlane32_swap_b32 v225, v229
  v_permlane32_swap_b32 v226, v230
  v_permlane32_swap_b32 v227, v231
  v_add_f32 v224, v224, v228
  v_add_f32 v225, v225, v229
  v_add_f32 v226, v226, v230
  v_add_f32 v227, v227, v231
  s_nop 0
  v_permlane16_swap_b32 v224, v226
  v_permlane16_swap_b32 v225, v227
  v_add_f32 v224, v224, v226
  v_add_f32 v225, v225, v227
  s_nop 0
  v_add_f32_dpp v224, v224, v224 row_ror:8 row_mask:0xf bank_mask:0x3
  s_nop 1
  v_add_f32_dpp v224, v225, v225 row_ror:8 row_mask:0xf bank_mask:0xc
  ds_write_b32 v9, v224 offset:32352
  s_waitcnt lgkmcnt(0)
  s_barrier
L_final:
  s_mov_b32 s84, s42
  s_mov_b32 s85, s43
  s_mov_b32 s86, 0x40000000
  s_mov_b32 s87, 0x20000
  s_mul_i32 s7, s3, 288
  v_lshl_add_u32 v1, v0, 3, s7
  s_mov_b32 exec_lo, -1
  s_mov_b32 exec_hi, 15
  ds_read_b64 v[24:25], v1 offset:30304
  ds_read_b64 v[26:27], v1 offset:32608
  ds_read_b64 v[28:29], v1 offset:34912
  ds_read_b64 v[30:31], v1 offset:37216
  v_mul_u32_u24 v5, 57, v0
  v_lshrrev_b32 v5, 9, v5
  v_mul_u32_u24 v6, 9, v5
  v_sub_u32 v6, v0, v6
  v_mul_u32_u24 v5, 5120, v5
  v_lshl_add_u32 v5, v6, 4, v5
  s_lshl_b32 s7, s5, 5
  s_lshl_b32 s10, s3, 2
  s_add_u32 s7, s7, s10
  s_mul_i32 s7, s7, 5120
  s_mul_i32 s10, s4, 144
  s_add_u32 s7, s7, s10
  s_add_u32 s26, s26, 1
  s_not_b32 s27, s26
  v_mov_b32 v33, s26
  v_mov_b32 v35, s27
  s_waitcnt lgkmcnt(0)
  v_add_f32 v24, v24, v26
  v_add_f32 v25, v25, v27
  v_add_f32 v28, v28, v30
  v_add_f32 v29, v29, v31
  v_add_f32 v32, v24, v28
  v_add_f32 v34, v25, v29
  buffer_store_dwordx4 v[32:35], v5, s[84:87], s7 offen sc1
  s_cmp_lg_u32 s3, 0
  s_cbranch_scc1 L_fin
  s_mov_b64 exec, -1
  v_mul_u32_u24 v5, 144, v3
  v_lshl_add_u32 v5, v4, 4, v5
  s_mul_i32 s7, s6, 5120
  v_cmp_gt_u32 vcc, 9, v4
  s_mov_b64 s[16:17], vcc
  s_mov_b64 s[18:19], vcc
  s_mov_b64 s[20:21], vcc
  s_mov_b64 s[22:23], vcc
  s_mov_b64 s[24:25], vcc
  s_mov_b64 s[28:29], vcc
  s_mov_b64 s[30:31], vcc
  s_mov_b64 s[32:33], vcc
  s_mov_b32 s80, s34
  s_mov_b32 s81, s35
  s_mov_b32 s82, 1152
  s_mov_b32 s83, 0x20000
  s_mul_i32 s11, s4, 36
  v_lshlrev_b32 v1, 2, v4
  buffer_load_dword v10, v1, s[80:83], s11 offen
  v_mov_b32 v6, 20768
  ds_read_b32 v8, v6
  s_mov_b32 s88, s38
  s_mov_b32 s89, s39
  s_mov_b32 s90, 9216
  s_mov_b32 s91, 0x20000
  s_mov_b32 s93, 0
L_poll:
  s_mov_b64 exec, s[16:17]
  s_cbranch_execz L_sk0
  buffer_load_dwordx4 v[40:43], v5, s[84:87], s7 offen offset:0 sc1
L_sk0:
  s_mov_b64 exec, s[18:19]
  s_cbranch_execz L_sk1
  buffer_load_dwordx4 v[44:47], v5, s[84:87], s7 offen offset:576 sc1
L_sk1:
  s_mov_b64 exec, s[20:21]
  s_cbranch_execz L_sk2
  buffer_load_dwordx4 v[48:51], v5, s[84:87], s7 offen offset:1152 sc1
L_sk2:
  s_mov_b64 exec, s[22:23]
  s_cbranch_execz L_sk3
  buffer_load_dwordx4 v[52:55], v5, s[84:87], s7 offen offset:1728 sc1
L_sk3:
  s_mov_b64 exec, s[24:25]
  s_cbranch_execz L_sk4
  buffer_load_dwordx4 v[56:59], v5, s[84:87], s7 offen offset:2304 sc1
L_sk4:
  s_mov_b64 exec, s[28:29]
  s_cbranch_execz L_sk5
  buffer_load_dwordx4 v[60:63], v5, s[84:87], s7 offen offset:2880 sc1
L_sk5:
  s_mov_b64 exec, s[30:31]
  s_cbranch_execz L_sk6
  buffer_load_dwordx4 v[64:67], v5, s[84:87], s7 offen offset:3456 sc1
L_sk6:
  s_mov_b64 exec, s[32:33]
  s_cbranch_execz L_sk7
  buffer_load_dwordx4 v[68:71], v5, s[84:87], s7 offen offset:4032 sc1
L_sk7:
  s_waitcnt vmcnt(0)
  s_mov_b64 s[10:11], 0
  s_mov_b64 exec, s[16:17]
  v_xor_b32 v16, s26, v41
  v_xor_b32 v17, s27, v43
  v_or_b32 v16, v16, v17
  v_cmp_ne_u32 s[16:17], 0, v16
  s_and_b64 s[16:17], s[16:17], exec
  s_or_b64 s[10:11], s[10:11], s[16:17]
  s_mov_b64 exec, s[18:19]
  v_xor_b32 v16, s26, v45
  v_xor_b32 v17, s27, v47
  v_or_b32 v16, v16, v17
  v_cmp_ne_u32 s[18:19], 0, v16
  s_and_b64 s[18:19], s[18:19], exec
  s_or_b64 s[10:11], s[10:11], s[18:19]
  s_mov_b64 exec, s[20:21]
  v_xor_b32 v16, s26, v49
  v_xor_b32 v17, s27, v51
  v_or_b32 v16, v16, v17
  v_cmp_ne_u32 s[20:21], 0, v16
  s_and_b64 s[20:21], s[20:21], exec
  s_or_b64 s[10:11], s[10:11], s[20:21]
  s_mov_b64 exec, s[22:23]
  v_xor_b32 v16, s26, v53
  v_xor_b32 v17, s27, v55
  v_or_b32 v16, v16, v17
  v_cmp_ne_u32 s[22:23], 0, v16
  s_and_b64 s[22:23], s[22:23], exec
  s_or_b64 s[10:11], s[10:11], s[22:23]
  s_mov_b64 exec, s[24:25]
  v_xor_b32 v16, s26, v57
  v_xor_b32 v17, s27, v59
  v_or_b32 v16, v16, v17
  v_cmp_ne_u32 s[24:25], 0, v16
  s_and_b64 s[24:25], s[24:25], exec
  s_or_b64 s[10:11], s[10:11], s[24:25]
  s_mov_b64 exec, s[28:29]
  v_xor_b32 v16, s26, v61
  v_xor_b32 v17, s27, v63
  v_or_b32 v16, v16, v17
  v_cmp_ne_u32 s[28:29], 0, v16
  s_and_b64 s[28:29], s[28:29], exec
  s_or_b64 s[10:11], s[10:11], s[28:29]
  s_mov_b64 exec, s[30:31]
  v_xor_b32 v16, s26, v65
  v_xor_b32 v17, s27, v67
  v_or_b32 v16, v16, v17
  v_cmp_ne_u32 s[30:31], 0, v16
  s_and_b64 s[30:31], s[30:31], exec
  s_or_b64 s[10:11], s[10:11], s[30:31]
  s_mov_b64 exec, s[32:33]
  v_xor_b32 v16, s26, v69
  v_xor_b32 v17, s27, v71
  v_or_b32 v16, v16, v17
  v_cmp_ne_u32 s[32:33], 0, v16
  s_and_b64 s[32:33], s[32:33], exec
  s_or_b64 s[10:11], s[10:11], s[32:33]
  s_cmp_eq_u64 s[10:11], 0
  s_cbranch_scc1 L_pdone
  s_sleep 2
  s_add_u32 s93, s93, 1
  s_cmp_lt_u32 s93, 100000
  s_cbranch_scc1 L_poll
L_pdone:
  s_mov_b64 exec, -1
  v_add_f32 v40, v40, v44
  v_add_f32 v42, v42, v46
  v_add_f32 v40, v40, v48
  v_add_f32 v42, v42, v50
  v_add_f32 v40, v40, v52
  v_add_f32 v42, v42, v54
  v_add_f32 v40, v40, v56
  v_add_f32 v42, v42, v58
  v_add_f32 v40, v40, v60
  v_add_f32 v42, v42, v62
  v_add_f32 v40, v40, v64
  v_add_f32 v42, v42, v66
  v_add_f32 v40, v40, v68
  v_add_f32 v42, v42, v70
  s_nop 1
  v_permlane32_swap_b32 v40, v42
  v_add_f32 v40, v40, v42
  v_mov_b32 v16, v40
  s_nop 1
  v_permlane16_swap_b32 v40, v16
  v_add_f32 v40, v40, v16
  v_mov_b32 v16, v40
  s_nop 1
  v_permlane32_swap_b32 v40, v16
  s_waitcnt lgkmcnt(0)
  v_sub_f32 v8, 1.0, v8
  v_lshlrev_b32 v17, 16, v10
  v_and_b32 v18, s92, v10
  v_fmac_f32 v40, v8, v17
  v_fmac_f32 v16, v8, v18
  v_cvt_pk_bf16_f32 v40, v40, v16
  s_mul_i32 s7, s5, 1152
  s_mul_i32 s12, s4, 36
  s_add_u32 s7, s7, s12
  s_mov_b64 exec, 0x1ff
  buffer_store_dword v40, v1, s[88:91], s7 offen
  s_cmp_lg_u32 s4, 0
  s_cbranch_scc1 L_fin
  s_mov_b64 exec, 1
  s_lshl_b32 s7, s5, 7
  s_add_u32 s7, s7, 3145728
  v_mov_b32 v5, s26
  v_mov_b32 v6, 0
  buffer_store_dword v5, v6, s[84:87], s7 offen
L_fin:
L_end:
  s_endpgm
.section .rodata,"a"
.p2align 6
.amdhsa_kernel gated_mix__mha_block_cached__mixer_channel_mlp__decode_kernel
  .amdhsa_next_free_vgpr 256
  .amdhsa_next_free_sgpr 102
  .amdhsa_accum_offset 256
  .amdhsa_group_segment_fixed_size 0
  .amdhsa_kernarg_size 112
  .amdhsa_user_sgpr_count 2
  .amdhsa_user_sgpr_kernarg_segment_ptr 1
  .amdhsa_system_sgpr_workgroup_id_x 1
.end_amdhsa_kernel
```
